```python
import torch

def _softmax(x, axis=-1):
    return torch.softmax(x, dim=axis)
def _gelu(x):
    return torch.nn.functional.gelu(x, approximate="tanh")
def _silu(x):
    return torch.nn.functional.silu(x)
def _sigmoid(x):
    return torch.sigmoid(x)
def _layernorm(x, axis=-1, eps=1e-5):
    m = x.mean(dim=axis, keepdim=True)
    v = x.var(dim=axis, keepdim=True, unbiased=False)
    return (x - m) / torch.sqrt(v + eps)
def _scatter_add(tgt, idx, src, axis=0):
    return tgt.clone().index_add_(axis, idx, src)
def _segment_sum(src, seg, n):
    out = torch.zeros((n,) + src.shape[1:], dtype=src.dtype)
    return out.index_add_(0, seg, src)
def _pad(x, pw):
    flat = tuple(v for pair in reversed(pw) for v in pair)
    return torch.nn.functional.pad(x, flat)

kernel_name = 'parallel_sum__ssm_conv_s4__moe_arch_mod__prompt'

def setup_inputs():

    _w = (lambda a: (lambda t: t.to(torch.bfloat16) if t.is_floating_point() else t)(torch.as_tensor(a)))
    def _A_setup():
        B, L, D, N = 1, 2048, 512, 128
        A_re = -(lambda _x: torch.exp(torch.as_tensor(_x)))((lambda *s: torch.randn(*s, dtype=torch.bfloat16) * 3.2)(D, N))
        A_im = torch.pi * (lambda *s: torch.randn(*s, dtype=torch.bfloat16) * 0.1)(D, N)
        B_re = (lambda *s: torch.randn(*s, dtype=torch.bfloat16) * 0.4)(D, N)
        B_im = (lambda *s: torch.randn(*s, dtype=torch.bfloat16) * 0.4)(D, N)
        C_re = (lambda *s: torch.randn(*s, dtype=torch.bfloat16) * 0.4)(D, N)
        C_im = (lambda *s: torch.randn(*s, dtype=torch.bfloat16) * 0.4)(D, N)
        log_dt = (lambda *s: torch.randn(*s, dtype=torch.bfloat16) * 0.1)(D) * 0.5 - 4.0
        Dskip = (lambda *s: torch.randn(*s, dtype=torch.bfloat16) * 0.1)(D)
        return {
            "u": _w((lambda *s: torch.randn(*s, dtype=torch.bfloat16) * 0.05)(B, L, D)),
            "A_re": _w(A_re),
            "A_im": _w(A_im),
            "B_re": _w(B_re),
            "B_im": _w(B_im),
            "C_re": _w(C_re),
            "C_im": _w(C_im),
            "log_dt": _w(log_dt),
            "Dskip": _w(Dskip),
        }
    _A_in = _A_setup()

    def _B_setup():
        B, S, D, F, C = 1, 2048, 512, 1792, 1
        return {
            "x": _w((lambda *s: torch.randn(*s, dtype=torch.bfloat16) * 0.05)(B, S, D)),
            "w_r": _w((lambda *s: torch.randn(*s, dtype=torch.bfloat16) * 0.05)(D)),
            "w_gate": _w((lambda *s: torch.randn(*s, dtype=torch.bfloat16) * 0.05)(D, F)),
            "w_up": _w((lambda *s: torch.randn(*s, dtype=torch.bfloat16) * 0.05)(D, F)),
            "w_down": _w((lambda *s: torch.randn(*s, dtype=torch.bfloat16) * 0.05)(F, D)),
        }
    _B_in = _B_setup()

    return {
        "A_u": _A_in["u"],
        "A_A_re": _A_in["A_re"],
        "A_A_im": _A_in["A_im"],
        "A_B_re": _A_in["B_re"],
        "A_B_im": _A_in["B_im"],
        "A_C_re": _A_in["C_re"],
        "A_C_im": _A_in["C_im"],
        "A_log_dt": _A_in["log_dt"],
        "A_Dskip": _A_in["Dskip"],
        "B_x": _B_in["x"],
        "B_w_r": _B_in["w_r"],
        "B_w_gate": _B_in["w_gate"],
        "B_w_up": _B_in["w_up"],
        "B_w_down": _B_in["w_down"],
    }

def reference(A_u, A_A_re, A_A_im, A_B_re, A_B_im, A_C_re, A_C_im, A_log_dt, A_Dskip, B_x, B_w_r, B_w_gate, B_w_up, B_w_down):
    def _A_ref(u, A_re, A_im, B_re, B_im, C_re, C_im, log_dt, Dskip):
        Bsz, L, D = u.shape
        dt = torch.exp(log_dt)[:, None]
        A = A_re + 1j * A_im
        Bc = B_re + 1j * B_im
        Cc = C_re + 1j * C_im
        logdA = dt * A
        dB = dt * Bc
        l = (lambda x, dt: x.to(dt))(torch.arange(L), A_re.dtype)
        P = torch.exp(logdA[:, :, None] * l[None, None, :])
        K = torch.einsum("dn,dnl,dn->dl", Cc, P, dB).real
        L2 = 2 * L
        Kp = _pad(K, ((0, 0), (0, L)))
        up = (lambda x, *d: x.permute(*d))(u, 0, 2, 1)
        up = _pad(up, ((0, 0), (0, 0), (0, L)))
        Kf = (lambda x, axes=(-2,-1): torch.fft.rfft2(x.float(), dim=axes))(Kp[:, None, :], axes=(-2, -1))
        Uf = (lambda x, axes=(-2,-1): torch.fft.rfft2(x.float(), dim=axes))(up[:, :, None, :], axes=(-2, -1))
        Yf = Uf * Kf[None, :, :, :]
        y = (lambda x, s, axes=(-2,-1): torch.fft.irfft2(x, s=s, dim=axes).to(torch.bfloat16))(Yf, (1, L2), axes=(-2, -1))[:, :, 0, :L]
        y = (lambda x, *d: x.permute(*d))(y, 0, 2, 1) + u * Dskip[None, None, :]
        return y

    def _B_ref(x, w_r, w_gate, w_up, w_down):
        B, S, D = x.shape
        C = 1
        r = x @ w_r
        idx = torch.argsort(-r, axis=-1)[:, :C]
        idx_e = (lambda x, n, axis: torch.repeat_interleave(x, n, dim=axis))(idx.reshape(B, C, 1), D, axis=2)
        x_sel = (lambda x, i, axis: torch.take_along_dim(x, i, dim=axis))(x, idx_e, axis=1)
        g = _silu(x_sel @ w_gate)
        u = x_sel @ w_up
        y = (g * u) @ w_down
        r_sel = _sigmoid((lambda x, i, axis: torch.take_along_dim(x, i, dim=axis))(r, idx, axis=1))
        y = y * r_sel.reshape(B, C, 1)
        b_off = (torch.arange(B) * S).reshape(B, 1)
        flat_idx = (idx + b_off).reshape(B * C)
        zero = (x * 0.0).reshape(B * S, D)
        upd = _scatter_add(zero, flat_idx, y.reshape(B * C, D), axis=0)
        return x + upd.reshape(B, S, D)

    x = A_u
    xn = _layernorm(x, axis=-1)
    return x + _A_ref(xn, A_A_re, A_A_im, A_B_re, A_B_im, A_C_re, A_C_im, A_log_dt, A_Dskip) + _B_ref(xn, B_w_r, B_w_gate, B_w_up, B_w_down)
```

```asm
; @launch grid=(256,1,1) block=(512,1,1) lds=142592
.amdgcn_target "amdgcn-amd-amdhsa--gfx950"
.text
.globl parallel_sum__ssm_conv_s4__moe_arch_mod__prompt_kernel
.p2align 8
.type parallel_sum__ssm_conv_s4__moe_arch_mod__prompt_kernel,@function
parallel_sum__ssm_conv_s4__moe_arch_mod__prompt_kernel:
    s_cmp_ge_u32 s2, 0x100
    s_cbranch_scc1 L_exit
    s_load_dwordx16 s[4:19], s[0:1], 0
    s_load_dwordx16 s[20:35], s[0:1], 64
    s_load_dwordx2 s[36:37], s[0:1], 128
    s_getpc_b64 s[44:45]
L_pc:
    v_lshrrev_b32 v2, 6, v0
    s_and_b32 s53, s2, 0xf8
    v_add_lshl_u32 v3, v2, s53, 7
    v_readfirstlane_b32 s39, v2
    v_min_u32 v3, L_end-L_pc-4, v3
    global_load_dword v255, v3, s[44:45]
    v_and_b32 v1, 63, v0
    s_and_b32 s52, s2, 7
    s_lshl_b32 s40, s52, 4
    s_bfe_u32 s54, s2, 0x40003
    s_add_u32 s40, s40, s54
    s_lshr_b32 s41, s2, 7
    v_lshlrev_b32 v2, 4, v1
    s_cmp_lt_u32 s39, 4
    s_cbranch_scc1 L_conv
    s_setprio 3
    s_sub_u32 s43, s39, 4
    s_lshl_b32 s55, s40, 14
    s_lshl_b32 s56, s43, 12
    s_add_u32 s55, s55, s56
    v_add_u32 v3, s55, v2
    v_mov_b32 v61, 141056
    s_cmp_lg_u32 s43, 3
    s_cbranch_scc1 L_noinit
    v_lshl_add_u32 v16, v1, 2, v61
    v_mov_b32 v17, 0
    ds_write_b32 v16, v17
L_noinit:
    s_waitcnt lgkmcnt(0)
    s_load_dword s38, s[36:37], 0
    s_cmp_lg_u32 s41, 1
    s_cbranch_scc1 L_noln
    global_load_dwordx4 v[4:7], v3, s[4:5] offset:0
    global_load_dwordx4 v[8:11], v3, s[4:5] offset:1024
    global_load_dwordx4 v[12:15], v3, s[4:5] offset:2048
    global_load_dwordx4 v[16:19], v3, s[4:5] offset:3072
    global_load_dwordx4 v[20:23], v2, s[24:25]
    v_lshlrev_b32 v24, 2, v1
    v_add_u32 v24, 141184, v24
    v_add_u32 v60, s43, v61
    v_cmp_eq_u32 vcc, 0, v1
    s_mov_b32 s42, 0
    s_nop 0
    v_cndmask_b32 v60, v24, v60, vcc
    s_lshl_b32 s57, s40, 4
    s_lshl_b32 s58, s43, 2
    s_add_u32 s57, s57, s58
    v_lshrrev_b32 v25, 4, v1
    v_add_u32 v55, s57, v25
    v_sub_u32 v52, 2047, v55
    v_lshlrev_b32 v55, 3, v55
    v_add_u32 v55, 8192, v55
    v_mov_b32 v53, 0x3b000000
    v_mov_b32 v54, 0xfff8fff8
    s_mul_i32 s58, s43, 4224
    s_lshr_b32 s59, s43, 1
    s_lshl_b32 s59, s59, 7
    s_add_u32 s58, s58, s59
    s_add_u32 s58, s58, 108160
    v_add_u32 v56, s58, v2
    v_bfe_u32 v24, v1, 2, 2
    v_mul_u32_u24 v24, 1056, v24
    v_lshl_add_u32 v24, v25, 4, v24
    v_and_b32 v26, 1, v1
    v_mul_u32_u24 v26, 8576, v26
    v_bfe_u32 v27, v1, 1, 1
    v_lshl_add_u32 v26, v27, 3, v26
    s_lshl_b32 s58, s43, 8
    s_add_u32 s58, s58, 108160
    v_add3_u32 v57, v24, v26, s58
    v_lshrrev_b32 v24, 3, v1
    v_lshlrev_b32 v24, 14, v24
    v_and_b32 v26, 7, v1
    v_lshl_add_u32 v24, v26, 4, v24
    s_lshl_b32 s58, s43, 19
    s_lshl_b32 s59, s40, 7
    s_add_u32 s58, s58, s59
    s_add_u32 s58, s58, 1048576
    v_add_u32 v58, s58, v24
    s_lshl_b32 s58, s2, 3
    s_add_u32 s58, s58, 4096
    v_mov_b32 v59, s58
    s_mov_b32 s54, 0x3b003b00
    s_mov_b32 s55, 0x3f803f80
    s_barrier
    s_waitcnt lgkmcnt(0)
    s_add_u32 s38, s38, 1
    s_and_b32 s46, s38, 0xffff
    s_lshr_b32 s47, s38, 16
    s_and_b32 s52, s43, 1
    s_mul_i32 s52, s52, 12
    s_lshr_b32 s52, s38, s52
    s_bfe_u32 s56, s52, 196608
    s_mul_i32 s56, s56, 0x10001
    s_bfe_u32 s57, s52, 196611
    s_mul_i32 s57, s57, 0x10001
    s_bfe_u32 s58, s52, 196614
    s_mul_i32 s58, s58, 0x10001
    s_bfe_u32 s59, s52, 196617
    s_mul_i32 s59, s59, 0x10001
    s_waitcnt vmcnt(0)
    v_dot2_f32_bf16 v24, v4, s54, 0
    v_dot2_f32_bf16 v28, v4, v4, 0
    v_dot2_f32_bf16 v32, v4, v20, 0
    v_dot2_f32_bf16 v36, v20, s55, 0
    v_dot2_f32_bf16 v25, v8, s54, 0
    v_dot2_f32_bf16 v29, v8, v8, 0
    v_dot2_f32_bf16 v33, v8, v20, 0
    v_dot2_f32_bf16 v26, v12, s54, 0
    v_dot2_f32_bf16 v30, v12, v12, 0
    v_dot2_f32_bf16 v34, v12, v20, 0
    v_dot2_f32_bf16 v27, v16, s54, 0
    v_dot2_f32_bf16 v31, v16, v16, 0
    v_dot2_f32_bf16 v35, v16, v20, 0
    v_dot2_f32_bf16 v24, v5, s54, v24
    v_dot2_f32_bf16 v28, v5, v5, v28
    v_dot2_f32_bf16 v32, v5, v21, v32
    v_dot2_f32_bf16 v36, v21, s55, v36
    v_dot2_f32_bf16 v25, v9, s54, v25
    v_dot2_f32_bf16 v29, v9, v9, v29
    v_dot2_f32_bf16 v33, v9, v21, v33
    v_dot2_f32_bf16 v26, v13, s54, v26
    v_dot2_f32_bf16 v30, v13, v13, v30
    v_dot2_f32_bf16 v34, v13, v21, v34
    v_dot2_f32_bf16 v27, v17, s54, v27
    v_dot2_f32_bf16 v31, v17, v17, v31
    v_dot2_f32_bf16 v35, v17, v21, v35
    v_dot2_f32_bf16 v24, v6, s54, v24
    v_dot2_f32_bf16 v28, v6, v6, v28
    v_dot2_f32_bf16 v32, v6, v22, v32
    v_dot2_f32_bf16 v36, v22, s55, v36
    v_dot2_f32_bf16 v25, v10, s54, v25
    v_dot2_f32_bf16 v29, v10, v10, v29
    v_dot2_f32_bf16 v33, v10, v22, v33
    v_dot2_f32_bf16 v26, v14, s54, v26
    v_dot2_f32_bf16 v30, v14, v14, v30
    v_dot2_f32_bf16 v34, v14, v22, v34
    v_dot2_f32_bf16 v27, v18, s54, v27
    v_dot2_f32_bf16 v31, v18, v18, v31
    v_dot2_f32_bf16 v35, v18, v22, v35
    v_dot2_f32_bf16 v24, v7, s54, v24
    v_dot2_f32_bf16 v28, v7, v7, v28
    v_dot2_f32_bf16 v32, v7, v23, v32
    v_dot2_f32_bf16 v36, v23, s55, v36
    v_dot2_f32_bf16 v25, v11, s54, v25
    v_dot2_f32_bf16 v29, v11, v11, v29
    v_dot2_f32_bf16 v33, v11, v23, v33
    v_dot2_f32_bf16 v26, v15, s54, v26
    v_dot2_f32_bf16 v30, v15, v15, v30
    v_dot2_f32_bf16 v34, v15, v23, v34
    v_dot2_f32_bf16 v27, v19, s54, v27
    v_dot2_f32_bf16 v31, v19, v19, v31
    v_dot2_f32_bf16 v35, v19, v23, v35
    v_mov_b32 v37, v36
    v_permlane32_swap_b32 v24, v26
    v_permlane32_swap_b32 v25, v27
    v_permlane32_swap_b32 v28, v30
    v_permlane32_swap_b32 v29, v31
    v_permlane32_swap_b32 v32, v34
    v_permlane32_swap_b32 v33, v35
    v_permlane32_swap_b32 v36, v37
    v_add_f32 v24, v24, v26
    v_add_f32 v25, v25, v27
    v_add_f32 v36, v36, v37
    v_add_f32 v28, v28, v30
    v_add_f32 v29, v29, v31
    v_mov_b32 v37, v36
    v_add_f32 v32, v32, v34
    v_add_f32 v33, v33, v35
    v_permlane16_swap_b32 v24, v25
    v_permlane16_swap_b32 v28, v29
    v_permlane16_swap_b32 v32, v33
    v_permlane16_swap_b32 v36, v37
    v_add_f32 v24, v24, v25
    v_add_f32 v28, v28, v29
    v_add_f32 v32, v32, v33
    v_add_f32 v36, v36, v37
    v_add_f32_dpp v24, v24, v24 row_shr:1 row_mask:0xf bank_mask:0xf bound_ctrl:0
    v_add_f32_dpp v28, v28, v28 row_shr:1 row_mask:0xf bank_mask:0xf bound_ctrl:0
    v_add_f32_dpp v32, v32, v32 row_shr:1 row_mask:0xf bank_mask:0xf bound_ctrl:0
    v_add_f32_dpp v36, v36, v36 row_shr:1 row_mask:0xf bank_mask:0xf bound_ctrl:0
    v_add_f32_dpp v24, v24, v24 row_shr:2 row_mask:0xf bank_mask:0xf bound_ctrl:0
    v_add_f32_dpp v28, v28, v28 row_shr:2 row_mask:0xf bank_mask:0xf bound_ctrl:0
    v_add_f32_dpp v32, v32, v32 row_shr:2 row_mask:0xf bank_mask:0xf bound_ctrl:0
    v_add_f32_dpp v36, v36, v36 row_shr:2 row_mask:0xf bank_mask:0xf bound_ctrl:0
    v_add_f32_dpp v24, v24, v24 row_shr:4 row_mask:0xf bank_mask:0xf bound_ctrl:0
    v_add_f32_dpp v28, v28, v28 row_shr:4 row_mask:0xf bank_mask:0xf bound_ctrl:0
    v_add_f32_dpp v32, v32, v32 row_shr:4 row_mask:0xf bank_mask:0xf bound_ctrl:0
    v_add_f32_dpp v36, v36, v36 row_shr:4 row_mask:0xf bank_mask:0xf bound_ctrl:0
    v_add_f32_dpp v24, v24, v24 row_shr:8 row_mask:0xf bank_mask:0xf bound_ctrl:0
    v_add_f32_dpp v28, v28, v28 row_shr:8 row_mask:0xf bank_mask:0xf bound_ctrl:0
    v_add_f32_dpp v32, v32, v32 row_shr:8 row_mask:0xf bank_mask:0xf bound_ctrl:0
    v_add_f32_dpp v36, v36, v36 row_shr:8 row_mask:0xf bank_mask:0xf bound_ctrl:0
    v_mul_f32 v42, v28, v53
    v_fma_f32 v42, -v24, v24, v42
    v_max_f32 v42, 0, v42
    v_cvt_pk_bf16_f32 v43, v24, v42
    v_and_b32 v42, 0xffff0000, v43
    v_lshlrev_b32 v38, 16, v43
    v_add_f32 v42, 0x3727c5ac, v42
    v_cvt_pk_bf16_f32 v42, v42, v42
    v_lshlrev_b32 v42, 16, v42
    v_sqrt_f32 v42, v42
    v_fma_f32 v44, -v38, v36, v32
    v_cvt_pk_bf16_f32 v42, v42, v42
    v_lshlrev_b32 v39, 16, v42
    v_rcp_f32 v40, v39
    v_or_b32 v42, s46, v38
    v_mul_f32 v44, v44, v40
    v_or_b32 v43, s47, v39
    v_ashrrev_i32 v45, 31, v44
    v_or_b32 v45, 0x80000000, v45
    v_xor_b32 v44, v44, v45
    v_and_b32 v44, 0xfffff800, v44
    v_or_b32 v44, v44, v52
    v_mov_b32 v46, 1
    s_mov_b32 exec_lo, 0x80008000
    s_mov_b32 exec_hi, 0x80008000
    ds_max_u32 v61, v44 offset:4
    s_mov_b64 exec, 0x8000
    ds_add_rtn_u32 v47, v61, v46 offset:24
    s_mov_b32 exec_lo, 0x80008000
    s_mov_b32 exec_hi, 0x80008000
    global_store_dwordx2 v55, v[42:43], s[36:37] sc1
    s_mov_b64 exec, -1
    v_mul_f32 v41, -v38, v40
    v_readlane_b32 s60, v40, 15
    v_readlane_b32 s62, v40, 31
    v_readlane_b32 s64, v40, 47
    v_readlane_b32 s66, v40, 63
    v_readlane_b32 s61, v41, 15
    v_readlane_b32 s63, v41, 31
    v_readlane_b32 s65, v41, 47
    v_readlane_b32 s67, v41, 63
    v_lshlrev_b32 v64, 16, v4
    v_and_b32 v65, 0xffff0000, v4
    v_lshlrev_b32 v66, 16, v5
    v_and_b32 v67, 0xffff0000, v5
    v_lshlrev_b32 v68, 16, v6
    v_and_b32 v69, 0xffff0000, v6
    v_lshlrev_b32 v70, 16, v7
    v_and_b32 v71, 0xffff0000, v7
    s_waitcnt lgkmcnt(0)
    v_readlane_b32 s52, v47, 15
    s_cmp_lg_u32 s52, 3
    s_cbranch_scc1 L_norout
    ds_read_b32 v48, v61 offset:4
    v_mov_b32 v49, s38
    s_mov_b64 exec, 1
    s_waitcnt lgkmcnt(0)
    global_store_dwordx2 v59, v[48:49], s[36:37] sc1
    s_mov_b64 exec, -1
L_norout:
    v_pk_fma_f32 v[64:65], v[64:65], s[60:61], s[60:61] op_sel:[0,0,1] op_sel_hi:[1,0,1]
    v_pk_fma_f32 v[66:67], v[66:67], s[60:61], s[60:61] op_sel:[0,0,1] op_sel_hi:[1,0,1]
    v_pk_fma_f32 v[68:69], v[68:69], s[60:61], s[60:61] op_sel:[0,0,1] op_sel_hi:[1,0,1]
    v_pk_fma_f32 v[70:71], v[70:71], s[60:61], s[60:61] op_sel:[0,0,1] op_sel_hi:[1,0,1]
    v_cvt_pk_f16_f32 v4, v64, v65
    v_cvt_pk_f16_f32 v5, v66, v67
    v_cvt_pk_f16_f32 v6, v68, v69
    v_cvt_pk_f16_f32 v7, v70, v71
    v_add_u32 v4, 0x40004, v4
    v_add_u32 v5, 0x40004, v5
    v_add_u32 v6, 0x40004, v6
    v_add_u32 v7, 0x40004, v7
    v_and_or_b32 v4, v4, v54, s56
    v_and_or_b32 v5, v5, v54, s56
    v_and_or_b32 v6, v6, v54, s56
    v_and_or_b32 v7, v7, v54, s56
    v_lshlrev_b32 v72, 16, v8
    v_and_b32 v73, 0xffff0000, v8
    v_lshlrev_b32 v74, 16, v9
    v_and_b32 v75, 0xffff0000, v9
    v_lshlrev_b32 v76, 16, v10
    v_and_b32 v77, 0xffff0000, v10
    v_lshlrev_b32 v78, 16, v11
    v_and_b32 v79, 0xffff0000, v11
    v_pk_fma_f32 v[72:73], v[72:73], s[62:63], s[62:63] op_sel:[0,0,1] op_sel_hi:[1,0,1]
    v_pk_fma_f32 v[74:75], v[74:75], s[62:63], s[62:63] op_sel:[0,0,1] op_sel_hi:[1,0,1]
    v_pk_fma_f32 v[76:77], v[76:77], s[62:63], s[62:63] op_sel:[0,0,1] op_sel_hi:[1,0,1]
    v_pk_fma_f32 v[78:79], v[78:79], s[62:63], s[62:63] op_sel:[0,0,1] op_sel_hi:[1,0,1]
    v_cvt_pk_f16_f32 v8, v72, v73
    v_cvt_pk_f16_f32 v9, v74, v75
    v_cvt_pk_f16_f32 v10, v76, v77
    v_cvt_pk_f16_f32 v11, v78, v79
    v_add_u32 v8, 0x40004, v8
    v_add_u32 v9, 0x40004, v9
    v_add_u32 v10, 0x40004, v10
    v_add_u32 v11, 0x40004, v11
    v_and_or_b32 v8, v8, v54, s57
    v_and_or_b32 v9, v9, v54, s57
    v_and_or_b32 v10, v10, v54, s57
    v_and_or_b32 v11, v11, v54, s57
    v_lshlrev_b32 v80, 16, v12
    v_and_b32 v81, 0xffff0000, v12
    v_lshlrev_b32 v82, 16, v13
    v_and_b32 v83, 0xffff0000, v13
    v_lshlrev_b32 v84, 16, v14
    v_and_b32 v85, 0xffff0000, v14
    v_lshlrev_b32 v86, 16, v15
    v_and_b32 v87, 0xffff0000, v15
    v_pk_fma_f32 v[80:81], v[80:81], s[64:65], s[64:65] op_sel:[0,0,1] op_sel_hi:[1,0,1]
    v_pk_fma_f32 v[82:83], v[82:83], s[64:65], s[64:65] op_sel:[0,0,1] op_sel_hi:[1,0,1]
    v_pk_fma_f32 v[84:85], v[84:85], s[64:65], s[64:65] op_sel:[0,0,1] op_sel_hi:[1,0,1]
    v_pk_fma_f32 v[86:87], v[86:87], s[64:65], s[64:65] op_sel:[0,0,1] op_sel_hi:[1,0,1]
    v_cvt_pk_f16_f32 v12, v80, v81
    v_cvt_pk_f16_f32 v13, v82, v83
    v_cvt_pk_f16_f32 v14, v84, v85
    v_cvt_pk_f16_f32 v15, v86, v87
    v_add_u32 v12, 0x40004, v12
    v_add_u32 v13, 0x40004, v13
    v_add_u32 v14, 0x40004, v14
    v_add_u32 v15, 0x40004, v15
    v_and_or_b32 v12, v12, v54, s58
    v_and_or_b32 v13, v13, v54, s58
    v_and_or_b32 v14, v14, v54, s58
    v_and_or_b32 v15, v15, v54, s58
    v_lshlrev_b32 v88, 16, v16
    v_and_b32 v89, 0xffff0000, v16
    v_lshlrev_b32 v90, 16, v17
    v_and_b32 v91, 0xffff0000, v17
    v_lshlrev_b32 v92, 16, v18
    v_and_b32 v93, 0xffff0000, v18
    v_lshlrev_b32 v94, 16, v19
    v_and_b32 v95, 0xffff0000, v19
    v_pk_fma_f32 v[88:89], v[88:89], s[66:67], s[66:67] op_sel:[0,0,1] op_sel_hi:[1,0,1]
    v_pk_fma_f32 v[90:91], v[90:91], s[66:67], s[66:67] op_sel:[0,0,1] op_sel_hi:[1,0,1]
    v_pk_fma_f32 v[92:93], v[92:93], s[66:67], s[66:67] op_sel:[0,0,1] op_sel_hi:[1,0,1]
    v_pk_fma_f32 v[94:95], v[94:95], s[66:67], s[66:67] op_sel:[0,0,1] op_sel_hi:[1,0,1]
    v_cvt_pk_f16_f32 v16, v88, v89
    v_cvt_pk_f16_f32 v17, v90, v91
    v_cvt_pk_f16_f32 v18, v92, v93
    v_cvt_pk_f16_f32 v19, v94, v95
    v_add_u32 v16, 0x40004, v16
    v_add_u32 v17, 0x40004, v17
    v_add_u32 v18, 0x40004, v18
    v_add_u32 v19, 0x40004, v19
    v_and_or_b32 v16, v16, v54, s59
    v_and_or_b32 v17, v17, v54, s59
    v_and_or_b32 v18, v18, v54, s59
    v_and_or_b32 v19, v19, v54, s59
    ds_write_b128 v56, v[4:7] offset:0
    ds_write_b128 v56, v[8:11] offset:1056
    ds_write_b128 v56, v[12:15] offset:2112
    ds_write_b128 v56, v[16:19] offset:3168
    ds_write_b8 v60, v46 offset:0
    v_add_u32 v24, 0x20000, v58
    v_add_u32 v25, 0x40000, v58
    v_add_u32 v26, 0x60000, v58
    s_waitcnt lgkmcnt(0)
    s_mov_b32 s53, 0
spin_1:
    ds_read_b32 v28, v61 offset:0
    s_waitcnt lgkmcnt(0)
    v_readfirstlane_b32 s52, v28
    s_add_u32 s53, s53, 1
    s_cmp_eq_u32 s52, 16843009
    s_cbranch_scc1 spun_2
    s_cmp_lt_u32 s53, 3200000
    s_sleep 1
    s_cbranch_scc1 spin_1
spun_2:
    ds_read_b64_tr_b16 v[4:5], v57 offset:0
    ds_read_b64_tr_b16 v[6:7], v57 offset:4224
    ds_read_b64_tr_b16 v[8:9], v57 offset:64
    ds_read_b64_tr_b16 v[10:11], v57 offset:4288
    ds_read_b64_tr_b16 v[12:13], v57 offset:128
    ds_read_b64_tr_b16 v[14:15], v57 offset:4352
    ds_read_b64_tr_b16 v[16:17], v57 offset:192
    ds_read_b64_tr_b16 v[18:19], v57 offset:4416
    s_waitcnt lgkmcnt(6)
    global_store_dwordx4 v58, v[4:7], s[36:37] sc1
    s_waitcnt lgkmcnt(4)
    global_store_dwordx4 v24, v[8:11], s[36:37] sc1
    s_waitcnt lgkmcnt(2)
    global_store_dwordx4 v25, v[12:15], s[36:37] sc1
    s_waitcnt lgkmcnt(0)
    global_store_dwordx4 v26, v[16:19], s[36:37] sc1
    s_cmp_ge_u32 s43, 2
    s_cbranch_scc1 L_xt
    s_cmp_eq_u32 s43, 0
    s_cbranch_scc1 L_rpoll
    s_endpgm
L_noln:
    s_cmp_lg_u32 s43, 2
    s_cbranch_scc1 L_notm
    v_mov_b32 v16, s55
    global_load_dword v252, v16, s[4:5]
L_notm:
    v_lshlrev_b32 v24, 2, v1
    v_add_u32 v24, 141184, v24
    v_add_u32 v60, s43, v61
    v_cmp_eq_u32 vcc, 0, v1
    s_mov_b32 s42, 0
    s_nop 0
    v_cndmask_b32 v60, v24, v60, vcc
    s_lshl_b32 s48, s40, 1
    s_add_u32 s48, s48, s43
    s_cmp_lt_u32 s40, 112
    s_cselect_b32 s42, 1, 0
    s_cmp_lt_u32 s43, 2
    s_cselect_b32 s42, s42, 0
    s_bitcmp0_b32 s43, 0
    s_cselect_b32 s60, s26, s28
    s_cselect_b32 s61, s27, s29
    s_cselect_b32 s62, 0, 16512
    s_add_u32 s62, s62, 108160
    v_lshrrev_b32 v16, 1, v1
    v_mul_u32_u24 v16, 3584, v16
    v_and_b32 v17, 1, v1
    v_lshl_add_u32 v16, v17, 4, v16
    s_lshl_b32 s63, s40, 5
    v_add_u32 v21, s63, v16
    s_lshl_b32 s63, s48, 13
    s_add_u32 s63, s63, 4096
    v_lshl_add_u32 v22, v1, 3, s63
    s_lshr_b32 s63, s43, 1
    s_add_u32 s64, s63, 16
    s_lshl_b32 s52, s2, 3
    s_add_u32 s52, s52, 4096
    v_mov_b32 v16, s52
    v_mov_b32 v18, 0
    s_barrier
    s_waitcnt lgkmcnt(0)
    s_add_u32 s38, s38, 1
    s_and_b32 s46, s38, 0xffff
    s_lshr_b32 s47, s38, 16
    s_cmp_lg_u32 s43, 0
    s_cbranch_scc1 L_nonull
    v_mov_b32 v19, s38
    s_mov_b64 exec, 1
    global_store_dwordx2 v16, v[18:19], s[36:37] sc1
    s_mov_b64 exec, -1
L_nonull:
    s_cmp_ge_u32 s40, 112
    s_cbranch_scc1 L_noffn
    s_cmp_eq_u32 s42, 0
    s_cbranch_scc1 L_noffn
    s_sleep 6
L_dma:
    s_lshl_b32 s66, s63, 10
    s_add_u32 m0, s66, s62
    s_mul_i32 s65, s63, 114688
    s_add_u32 s66, s60, s65
    s_addc_u32 s67, s61, 0
    s_add_u32 s63, s63, 1
    s_cmp_lg_u32 s63, s64
    global_load_lds_dwordx4 v21, s[66:67]
    s_cbranch_scc1 L_dma
    s_cmp_eq_u32 s42, 0
    s_cbranch_scc1 L_nowd
    global_load_dwordx2 v[64:65], v22, s[30:31] offset:-4096
    global_load_dwordx2 v[66:67], v22, s[30:31] offset:-3584
    global_load_dwordx2 v[68:69], v22, s[30:31] offset:-3072
    global_load_dwordx2 v[70:71], v22, s[30:31] offset:-2560
    global_load_dwordx2 v[72:73], v22, s[30:31] offset:-2048
    global_load_dwordx2 v[74:75], v22, s[30:31] offset:-1536
    global_load_dwordx2 v[76:77], v22, s[30:31] offset:-1024
    global_load_dwordx2 v[78:79], v22, s[30:31] offset:-512
    global_load_dwordx2 v[80:81], v22, s[30:31] offset:0
    global_load_dwordx2 v[82:83], v22, s[30:31] offset:512
    global_load_dwordx2 v[84:85], v22, s[30:31] offset:1024
    global_load_dwordx2 v[86:87], v22, s[30:31] offset:1536
    global_load_dwordx2 v[88:89], v22, s[30:31] offset:2048
    global_load_dwordx2 v[90:91], v22, s[30:31] offset:2560
    global_load_dwordx2 v[92:93], v22, s[30:31] offset:3072
    global_load_dwordx2 v[94:95], v22, s[30:31] offset:3584
L_nowd:
L_noffn:
    s_cmp_ge_u32 s43, 2
    s_cbranch_scc1 L_xt
    s_cmp_eq_u32 s42, 1
    s_cbranch_scc1 L_ffnprep
    s_cmp_eq_u32 s43, 0
    s_cbranch_scc1 L_hop2c
    s_endpgm
L_ffnprep:
    s_mov_b32 s54, 0x05040100
    s_mov_b32 s55, 0x07060302
    v_bfe_u32 v16, v1, 2, 2
    v_lshrrev_b32 v17, 4, v1
    v_lshl_add_u32 v16, v17, 3, v16
    v_lshlrev_b32 v16, 5, v16
    v_and_b32 v17, 1, v1
    v_lshl_add_u32 v16, v17, 3, v16
    v_bfe_u32 v17, v1, 1, 1
    v_mul_u32_u24 v17, 16512, v17
    s_lshl_b32 s56, s43, 4
    s_add_u32 s56, s56, 108160
    v_add3_u32 v20, v16, v17, s56
    v_mov_b32 v16, 1
    s_waitcnt vmcnt(24)
    ds_write_b8 v60, v16 offset:16
    s_waitcnt lgkmcnt(0)
    s_mov_b32 s53, 0
spin_3:
    ds_read_b32 v18, v61 offset:16
    s_waitcnt lgkmcnt(0)
    v_readfirstlane_b32 s52, v18
    s_add_u32 s53, s53, 1
    s_cmp_eq_u32 s52, 257
    s_cbranch_scc1 spun_4
    s_cmp_lt_u32 s53, 3200000
    s_sleep 1
    s_cbranch_scc1 spin_3
spun_4:
    ds_read_b64_tr_b16 v[128:129], v20 offset:0
    ds_read_b64_tr_b16 v[130:131], v20 offset:128
    ds_read_b64_tr_b16 v[132:133], v20 offset:1024
    ds_read_b64_tr_b16 v[134:135], v20 offset:1152
    ds_read_b64_tr_b16 v[136:137], v20 offset:2048
    ds_read_b64_tr_b16 v[138:139], v20 offset:2176
    ds_read_b64_tr_b16 v[140:141], v20 offset:3072
    ds_read_b64_tr_b16 v[142:143], v20 offset:3200
    ds_read_b64_tr_b16 v[144:145], v20 offset:4096
    ds_read_b64_tr_b16 v[146:147], v20 offset:4224
    ds_read_b64_tr_b16 v[148:149], v20 offset:5120
    ds_read_b64_tr_b16 v[150:151], v20 offset:5248
    ds_read_b64_tr_b16 v[152:153], v20 offset:6144
    ds_read_b64_tr_b16 v[154:155], v20 offset:6272
    ds_read_b64_tr_b16 v[156:157], v20 offset:7168
    ds_read_b64_tr_b16 v[158:159], v20 offset:7296
    s_waitcnt vmcnt(16)
    ds_write_b8 v60, v16 offset:8
    s_waitcnt lgkmcnt(0)
    s_mov_b32 s53, 0
spin_5:
    ds_read_b32 v18, v61 offset:8
    s_waitcnt lgkmcnt(0)
    v_readfirstlane_b32 s52, v18
    s_add_u32 s53, s53, 1
    s_cmp_eq_u32 s52, 257
    s_cbranch_scc1 spun_6
    s_cmp_lt_u32 s53, 3200000
    s_sleep 1
    s_cbranch_scc1 spin_5
spun_6:
    ds_read_b64_tr_b16 v[160:161], v20 offset:8192
    ds_read_b64_tr_b16 v[162:163], v20 offset:8320
    ds_read_b64_tr_b16 v[164:165], v20 offset:9216
    ds_read_b64_tr_b16 v[166:167], v20 offset:9344
    ds_read_b64_tr_b16 v[168:169], v20 offset:10240
    ds_read_b64_tr_b16 v[170:171], v20 offset:10368
    ds_read_b64_tr_b16 v[172:173], v20 offset:11264
    ds_read_b64_tr_b16 v[174:175], v20 offset:11392
    ds_read_b64_tr_b16 v[176:177], v20 offset:12288
    ds_read_b64_tr_b16 v[178:179], v20 offset:12416
    ds_read_b64_tr_b16 v[180:181], v20 offset:13312
    ds_read_b64_tr_b16 v[182:183], v20 offset:13440
    ds_read_b64_tr_b16 v[184:185], v20 offset:14336
    ds_read_b64_tr_b16 v[186:187], v20 offset:14464
    ds_read_b64_tr_b16 v[188:189], v20 offset:15360
    ds_read_b64_tr_b16 v[190:191], v20 offset:15488
    s_waitcnt vmcnt(0)
    v_perm_b32 v96, v72, v64, s54
    v_perm_b32 v97, v72, v64, s55
    v_perm_b32 v98, v73, v65, s54
    v_perm_b32 v99, v73, v65, s55
    v_perm_b32 v100, v74, v66, s54
    v_perm_b32 v101, v74, v66, s55
    v_perm_b32 v102, v75, v67, s54
    v_perm_b32 v103, v75, v67, s55
    v_perm_b32 v104, v88, v80, s54
    v_perm_b32 v105, v88, v80, s55
    v_perm_b32 v106, v89, v81, s54
    v_perm_b32 v107, v89, v81, s55
    v_perm_b32 v108, v90, v82, s54
    v_perm_b32 v109, v90, v82, s55
    v_perm_b32 v110, v91, v83, s54
    v_perm_b32 v111, v91, v83, s55
    v_perm_b32 v112, v76, v68, s54
    v_perm_b32 v113, v76, v68, s55
    v_perm_b32 v114, v77, v69, s54
    v_perm_b32 v115, v77, v69, s55
    v_perm_b32 v116, v78, v70, s54
    v_perm_b32 v117, v78, v70, s55
    v_perm_b32 v118, v79, v71, s54
    v_perm_b32 v119, v79, v71, s55
    v_perm_b32 v120, v92, v84, s54
    v_perm_b32 v121, v92, v84, s55
    v_perm_b32 v122, v93, v85, s54
    v_perm_b32 v123, v93, v85, s55
    v_perm_b32 v124, v94, v86, s54
    v_perm_b32 v125, v94, v86, s55
    v_perm_b32 v126, v95, v87, s54
    v_perm_b32 v127, v95, v87, s55
    v_lshrrev_b32 v21, 4, v1
    v_lshlrev_b32 v21, 4, v21
    v_add_u32 v21, 141568, v21
    s_waitcnt lgkmcnt(0)
    s_mov_b32 s53, 0
spin_7:
    ds_read_b32 v18, v61 offset:12
    s_waitcnt lgkmcnt(0)
    v_readfirstlane_b32 s52, v18
    s_add_u32 s53, s53, 1
    s_cmp_eq_u32 s52, 1
    s_cbranch_scc1 spun_8
    s_cmp_lt_u32 s53, 3200000
    s_sleep 1
    s_cbranch_scc1 spin_7
spun_8:
    ds_read_b128 v[192:195], v21 offset:0
    ds_read_b128 v[196:199], v21 offset:64
    ds_read_b128 v[200:203], v21 offset:128
    s_waitcnt lgkmcnt(2)
    ds_read_b128 v[204:207], v21 offset:192
    ds_read_b128 v[208:211], v21 offset:256
    v_mfma_f32_16x16x32_bf16 v[32:35], v[128:131], v[192:195], 0
    s_waitcnt lgkmcnt(3)
    ds_read_b128 v[212:215], v21 offset:320
    ds_read_b128 v[216:219], v21 offset:384
    v_mfma_f32_16x16x32_bf16 v[32:35], v[132:135], v[196:199], v[32:35]
    s_waitcnt lgkmcnt(4)
    ds_read_b128 v[220:223], v21 offset:448
    ds_read_b128 v[192:195], v21 offset:512
    v_mfma_f32_16x16x32_bf16 v[32:35], v[136:139], v[200:203], v[32:35]
    s_waitcnt lgkmcnt(5)
    ds_read_b128 v[196:199], v21 offset:576
    ds_read_b128 v[200:203], v21 offset:640
    v_mfma_f32_16x16x32_bf16 v[32:35], v[140:143], v[204:207], v[32:35]
    s_waitcnt lgkmcnt(6)
    ds_read_b128 v[204:207], v21 offset:704
    v_mfma_f32_16x16x32_bf16 v[32:35], v[144:147], v[208:211], v[32:35]
    s_waitcnt lgkmcnt(6)
    ds_read_b128 v[208:211], v21 offset:768
    v_mfma_f32_16x16x32_bf16 v[32:35], v[148:151], v[212:215], v[32:35]
    s_waitcnt lgkmcnt(6)
    ds_read_b128 v[212:215], v21 offset:832
    v_mfma_f32_16x16x32_bf16 v[32:35], v[152:155], v[216:219], v[32:35]
    s_waitcnt lgkmcnt(6)
    ds_read_b128 v[216:219], v21 offset:896
    v_mfma_f32_16x16x32_bf16 v[32:35], v[156:159], v[220:223], v[32:35]
    s_waitcnt lgkmcnt(6)
    ds_read_b128 v[220:223], v21 offset:960
    v_mfma_f32_16x16x32_bf16 v[32:35], v[160:163], v[192:195], v[32:35]
    s_waitcnt lgkmcnt(6)
    v_mfma_f32_16x16x32_bf16 v[32:35], v[164:167], v[196:199], v[32:35]
    s_waitcnt lgkmcnt(5)
    v_mfma_f32_16x16x32_bf16 v[32:35], v[168:171], v[200:203], v[32:35]
    s_waitcnt lgkmcnt(4)
    v_mfma_f32_16x16x32_bf16 v[32:35], v[172:175], v[204:207], v[32:35]
    s_waitcnt lgkmcnt(3)
    v_mfma_f32_16x16x32_bf16 v[32:35], v[176:179], v[208:211], v[32:35]
    s_waitcnt lgkmcnt(2)
    v_mfma_f32_16x16x32_bf16 v[32:35], v[180:183], v[212:215], v[32:35]
    s_waitcnt lgkmcnt(1)
    v_mfma_f32_16x16x32_bf16 v[32:35], v[184:187], v[216:219], v[32:35]
    s_waitcnt lgkmcnt(0)
    v_mfma_f32_16x16x32_bf16 v[32:35], v[188:191], v[220:223], v[32:35]
    s_lshr_b32 s59, s38, 8
    s_lshr_b32 s60, s38, 16
    s_lshr_b32 s61, s38, 24
    s_mul_i32 s52, s48, 2176
    s_add_u32 s52, s52, 65536
    v_add_u32 v20, s52, v2
    v_mov_b32 v21, 0xff
    s_nop 0
    v_permlane32_swap_b32 v32, v33
    v_permlane32_swap_b32 v34, v35
    v_mul_f32 v36, 0xbfb8aa3b, v32
    v_mul_f32 v37, 0xbfb8aa3b, v34
    v_exp_f32 v36, v36
    v_exp_f32 v37, v37
    v_mul_f32 v32, v32, v33
    v_add_f32 v36, 1.0, v36
    v_add_f32 v37, 1.0, v37
    v_rcp_f32 v36, v36
    v_rcp_f32 v37, v37
    v_mul_f32 v34, v34, v35
    v_mul_f32 v36, v36, v32
    v_mul_f32 v37, v37, v34
    v_cvt_pk_bf16_f32 v36, v36, v37
    s_nop 0
    v_readlane_b32 s64, v36, 0
    v_readlane_b32 s65, v36, 16
    v_readlane_b32 s66, v36, 32
    v_readlane_b32 s67, v36, 48
    v_dot2_f32_bf16 v40, v96, s64, 0
    v_dot2_f32_bf16 v41, v97, s64, 0
    v_dot2_f32_bf16 v42, v98, s64, 0
    v_dot2_f32_bf16 v43, v99, s64, 0
    v_dot2_f32_bf16 v40, v104, s65, v40
    v_dot2_f32_bf16 v41, v105, s65, v41
    v_dot2_f32_bf16 v42, v106, s65, v42
    v_dot2_f32_bf16 v43, v107, s65, v43
    v_dot2_f32_bf16 v40, v112, s66, v40
    v_dot2_f32_bf16 v41, v113, s66, v41
    v_dot2_f32_bf16 v42, v114, s66, v42
    v_dot2_f32_bf16 v43, v115, s66, v43
    v_dot2_f32_bf16 v40, v120, s67, v40
    v_dot2_f32_bf16 v41, v121, s67, v41
    v_dot2_f32_bf16 v42, v122, s67, v42
    v_dot2_f32_bf16 v43, v123, s67, v43
    v_bfi_b32 v40, v21, s38, v40
    v_bfi_b32 v41, v21, s59, v41
    v_bfi_b32 v42, v21, s60, v42
    v_bfi_b32 v43, v21, s61, v43
    v_dot2_f32_bf16 v44, v100, s64, 0
    v_dot2_f32_bf16 v45, v101, s64, 0
    v_dot2_f32_bf16 v46, v102, s64, 0
    v_dot2_f32_bf16 v47, v103, s64, 0
    v_dot2_f32_bf16 v44, v108, s65, v44
    v_dot2_f32_bf16 v45, v109, s65, v45
    v_dot2_f32_bf16 v46, v110, s65, v46
    v_dot2_f32_bf16 v47, v111, s65, v47
    v_dot2_f32_bf16 v44, v116, s66, v44
    v_dot2_f32_bf16 v45, v117, s66, v45
    v_dot2_f32_bf16 v46, v118, s66, v46
    v_dot2_f32_bf16 v47, v119, s66, v47
    v_dot2_f32_bf16 v44, v124, s67, v44
    v_dot2_f32_bf16 v45, v125, s67, v45
    v_dot2_f32_bf16 v46, v126, s67, v46
    v_dot2_f32_bf16 v47, v127, s67, v47
    global_store_dwordx4 v20, v[40:43], s[36:37] sc1
    v_bfi_b32 v44, v21, s38, v44
    v_bfi_b32 v45, v21, s59, v45
    v_bfi_b32 v46, v21, s60, v46
    v_bfi_b32 v47, v21, s61, v47
    global_store_dwordx4 v20, v[44:47], s[36:37] offset:1024 sc1
    s_cmp_eq_u32 s43, 0
    s_cbranch_scc1 L_hop2
    s_endpgm
L_rpoll:
    s_waitcnt vmcnt(0) lgkmcnt(0)
    s_cmp_eq_u32 s41, 1
    s_cbranch_scc1 L_rp0
    s_sleep 32
L_rp0:
    v_add_u32 v40, 4096, v2
    s_mov_b32 s53, 0
L_rp1:
    global_load_dwordx4 v[44:47], v40, s[36:37] sc1
    global_load_dwordx4 v[48:51], v40, s[36:37] offset:1024 sc1
    s_add_u32 s53, s53, 1
    s_waitcnt vmcnt(0)
    v_xor_b32 v45, s38, v45
    v_xor_b32 v47, s38, v47
    v_xor_b32 v49, s38, v49
    v_xor_b32 v51, s38, v51
    v_max3_u32 v44, v44, v46, v48
    v_or3_b32 v45, v45, v47, v49
    v_max_u32 v44, v44, v50
    v_or_b32 v45, v45, v51
    v_cmp_ne_u32 vcc, 0, v45
    s_cbranch_vccz L_rp2
    s_cmp_lt_u32 s53, 200000
    s_cbranch_scc1 L_rp1
L_rp2:
    v_max_u32_dpp v44, v44, v44 row_shr:1 row_mask:0xf bank_mask:0xf bound_ctrl:0
    s_nop 1
    v_max_u32_dpp v44, v44, v44 row_shr:2 row_mask:0xf bank_mask:0xf bound_ctrl:0
    s_nop 1
    v_max_u32_dpp v44, v44, v44 row_shr:4 row_mask:0xf bank_mask:0xf bound_ctrl:0
    s_nop 1
    v_max_u32_dpp v44, v44, v44 row_shr:8 row_mask:0xf bank_mask:0xf bound_ctrl:0
    s_nop 1
    v_max_u32_dpp v44, v44, v44 row_bcast:15 row_mask:0xa bank_mask:0xf
    s_nop 1
    v_max_u32_dpp v44, v44, v44 row_bcast:31 row_mask:0xc bank_mask:0xf
    s_nop 0
    v_readlane_b32 s49, v44, 63
    s_and_b32 s50, s49, 0x7ff
    s_sub_u32 s50, 2047, s50
    s_lshl_b32 s66, s50, 10
    s_lshl_b32 s67, s50, 3
    s_add_u32 s67, s67, 8192
    v_add_u32 v41, s66, v2
    v_mov_b32 v42, s67
    s_cmp_lt_u32 s40, 112
    s_cselect_b32 s68, 1, 0
    s_cmp_lg_u32 s41, 1
    s_cselect_b32 s68, s68, 0
    s_cmp_eq_u32 s68, 0
    s_cbranch_scc1 L_rp3
    global_load_dwordx4 v[44:47], v41, s[4:5]
    global_load_dwordx2 v[48:49], v42, s[36:37] sc1
L_rp3:
    v_mov_b32 v112, 1
    v_mov_b32 v113, s50
    v_mov_b32 v114, s49
    s_mov_b64 exec, 1
    ds_write_b96 v61, v[112:114] offset:96
    s_cmp_lg_u32 s2, 0
    s_cbranch_scc1 L_rp5
    v_mov_b32 v116, 0
    v_mov_b32 v117, s38
    global_store_dword v116, v117, s[36:37] sc1
L_rp5:
    s_mov_b64 exec, -1
    s_cmp_eq_u32 s41, 1
    s_cbranch_scc1 L_hop2b
    s_cmp_eq_u32 s68, 0
    s_cbranch_scc1 L_xt1
    v_add_u32 v41, 141568, v2
    s_mov_b32 s53, 0
L_st1:
    s_waitcnt vmcnt(0)
    v_xor_b32 v48, s46, v48
    v_xor_b32 v49, s47, v49
    v_or_b32 v50, v48, v49
    v_and_b32 v50, 0xffff, v50
    v_cmp_ne_u32 vcc, 0, v50
    s_cbranch_vccz L_st2
    s_add_u32 s53, s53, 1
    s_cmp_ge_u32 s53, 200000
    s_cbranch_scc1 L_st2
    global_load_dwordx2 v[48:49], v42, s[36:37] sc1
    s_branch L_st1
L_st2:
    v_rcp_f32 v50, v49
    v_lshlrev_b32 v116, 16, v44
    v_and_b32 v117, 0xffff0000, v44
    v_lshlrev_b32 v118, 16, v45
    v_and_b32 v119, 0xffff0000, v45
    v_lshlrev_b32 v120, 16, v46
    v_and_b32 v121, 0xffff0000, v46
    v_lshlrev_b32 v122, 16, v47
    v_and_b32 v123, 0xffff0000, v47
    v_mul_f32 v51, -v48, v50
    v_pk_fma_f32 v[116:117], v[116:117], v[50:51], v[50:51] op_sel:[0,0,1] op_sel_hi:[1,0,1]
    v_pk_fma_f32 v[118:119], v[118:119], v[50:51], v[50:51] op_sel:[0,0,1] op_sel_hi:[1,0,1]
    v_pk_fma_f32 v[120:121], v[120:121], v[50:51], v[50:51] op_sel:[0,0,1] op_sel_hi:[1,0,1]
    v_pk_fma_f32 v[122:123], v[122:123], v[50:51], v[50:51] op_sel:[0,0,1] op_sel_hi:[1,0,1]
    v_cvt_pk_bf16_f32 v44, v116, v117
    v_cvt_pk_bf16_f32 v45, v118, v119
    v_cvt_pk_bf16_f32 v46, v120, v121
    v_cvt_pk_bf16_f32 v47, v122, v123
    ds_write_b128 v41, v[44:47]
    s_mov_b64 exec, 1
    ds_write_b32 v61, v112 offset:12
    s_mov_b64 exec, -1
    s_branch L_xt2
L_hop2c:
    s_waitcnt lgkmcnt(0)
    s_mov_b32 s53, 0
spin_9:
    ds_read_b32 v18, v61 offset:96
    s_waitcnt lgkmcnt(0)
    v_readfirstlane_b32 s52, v18
    s_add_u32 s53, s53, 1
    s_cmp_eq_u32 s52, 1
    s_cbranch_scc1 spun_10
    s_cmp_lt_u32 s53, 3200000
    s_sleep 1
    s_cbranch_scc1 spin_9
spun_10:
L_hop2b:
    s_sleep 26
L_hop2:
    ds_read_b96 v[16:18], v61 offset:96
    s_waitcnt lgkmcnt(0)
    v_readfirstlane_b32 s50, v17
    v_readfirstlane_b32 s49, v18
    s_lshr_b32 s52, s50, 8
    s_add_u32 s52, s52, 6
    s_and_b32 s52, s52, 7
    s_lshr_b32 s52, s52, 2
    s_xor_b32 s52, s52, 1
    s_cmp_eq_u32 s52, s41
    s_cbranch_scc1 L_h1
    s_endpgm
L_h1:
    s_and_b32 s58, s38, 0xff
    s_bfe_u32 s59, s38, 0x80008
    s_bfe_u32 s60, s38, 0x80010
    s_lshr_b32 s61, s38, 24
    s_lshl_b32 s52, s40, 4
    s_add_u32 s52, s52, 65536
    v_mul_u32_u24 v20, 2176, v1
    v_add_u32 v20, s52, v20
    v_add_u32 v21, 139264, v20
    v_add_u32 v22, 278528, v20
    v_add_u32 v23, 417792, v20
    v_mov_b32 v36, s58
    v_mov_b32 v37, s59
    v_mov_b32 v38, s60
    v_mov_b32 v39, s61
    s_and_b32 s52, s49, 0xfffff800
    s_xor_b32 s54, s52, 0x80000000
    s_not_b32 s55, s52
    s_bitcmp1_b32 s52, 31
    s_cselect_b32 s52, s54, s55
    v_mov_b32 v44, s52
    v_mul_f32 v44, 0xbfb8aa3b, v44
    v_exp_f32 v44, v44
    s_mov_b32 s53, 0
    v_add_f32 v44, 1.0, v44
    v_rcp_f32 v44, v44
    s_lshl_b32 s52, s50, 10
    s_lshl_b32 s54, s40, 3
    s_add_u32 s52, s52, s54
    v_lshrrev_b32 v45, 4, v1
    v_and_b32 v46, 1, v45
    v_lshrrev_b32 v45, 1, v45
    v_lshl_add_u32 v45, v46, 1, v45
    v_lshl_add_u32 v46, v45, 2, v61
    v_lshl_add_u32 v45, v45, 1, s52
    s_sleep 12
L_h2:
    global_load_dwordx4 v[24:27], v20, s[36:37] sc1
    global_load_dwordx4 v[28:31], v21, s[36:37] sc1
    global_load_dwordx4 v[32:35], v22, s[36:37] sc1
    s_mov_b32 exec_hi, 0
    global_load_dwordx4 v[36:39], v23, s[36:37] sc1
    s_mov_b32 exec_hi, -1
    s_add_u32 s53, s53, 1
    s_waitcnt vmcnt(0)
    v_xor_b32 v40, v24, v28
    v_xor_b32 v41, v25, v29
    v_xor_b32 v42, v26, v30
    v_xor_b32 v43, v27, v31
    v_xor_b32 v48, v32, v36
    v_xor_b32 v49, v33, v37
    v_xor_b32 v50, v34, v38
    v_xor_b32 v51, v35, v39
    v_xor_b32 v16, s58, v24
    v_xor_b32 v17, s59, v25
    v_xor_b32 v18, s60, v26
    v_xor_b32 v19, s61, v27
    v_or3_b32 v40, v40, v41, v42
    v_or3_b32 v48, v48, v49, v50
    v_or3_b32 v16, v16, v17, v18
    v_xor_b32 v41, v24, v32
    v_xor_b32 v42, v25, v33
    v_xor_b32 v49, v26, v34
    v_xor_b32 v50, v27, v35
    v_or3_b32 v40, v40, v43, v48
    v_or3_b32 v16, v16, v19, v51
    v_or3_b32 v41, v41, v42, v49
    v_or3_b32 v40, v40, v16, v50
    v_or_b32 v40, v40, v41
    v_and_b32 v40, 0xff, v40
    v_cmp_ne_u32 vcc, 0, v40
    s_cbranch_vccz L_h3
    s_cmp_lt_u32 s53, 200000
    s_cbranch_scc1 L_h2
L_h3:
    v_pk_add_f32 v[24:25], v[24:25], v[28:29]
    v_pk_add_f32 v[26:27], v[26:27], v[30:31]
    v_pk_add_f32 v[32:33], v[32:33], v[36:37]
    v_pk_add_f32 v[34:35], v[34:35], v[38:39]
    v_pk_add_f32 v[24:25], v[24:25], v[32:33]
    v_pk_add_f32 v[26:27], v[26:27], v[34:35]
    s_nop 0
    v_permlane32_swap_b32 v24, v25
    v_permlane32_swap_b32 v26, v27
    v_add_f32 v24, v24, v25
    v_add_f32 v26, v26, v27
    s_nop 1
    v_permlane16_swap_b32 v24, v26
    v_add_f32 v24, v24, v26
    s_nop 1
    v_add_f32_dpp v24, v24, v24 row_shr:1 row_mask:0xf bank_mask:0xf bound_ctrl:0
    s_nop 1
    v_add_f32_dpp v24, v24, v24 row_shr:2 row_mask:0xf bank_mask:0xf bound_ctrl:0
    s_nop 1
    v_add_f32_dpp v24, v24, v24 row_shr:4 row_mask:0xf bank_mask:0xf bound_ctrl:0
    s_nop 1
    v_add_f32_dpp v24, v24, v24 row_shr:8 row_mask:0xf bank_mask:0xf bound_ctrl:0
    s_waitcnt lgkmcnt(0)
    s_mov_b32 s53, 0
spin_11:
    ds_read_b32 v18, v61 offset:48
    s_waitcnt lgkmcnt(0)
    v_readfirstlane_b32 s52, v18
    s_add_u32 s53, s53, 1
    s_cmp_eq_u32 s52, 1
    s_cbranch_scc1 spun_12
    s_cmp_lt_u32 s53, 3200000
    s_sleep 1
    s_cbranch_scc1 spin_11
spun_12:
    ds_read_b32 v25, v46 offset:64
    s_waitcnt lgkmcnt(0)
    v_fma_f32 v25, v24, v44, v25
    v_cvt_pk_bf16_f32 v25, v25, v25
    s_mov_b32 exec_lo, 0x80008000
    s_mov_b32 exec_hi, 0x80008000
    global_store_short v45, v25, s[32:33]
    s_endpgm
L_xt:
    s_sub_u32 s43, s43, 2
    v_subrev_u32 v60, 2, v60
    s_bfe_u32 s54, s38, 196608
    s_bfe_u32 s52, s38, 196611
    s_lshl_b32 s52, s52, 16
    s_or_b32 s54, s54, s52
    s_bfe_u32 s55, s38, 196614
    s_bfe_u32 s52, s38, 196617
    s_lshl_b32 s52, s52, 16
    s_or_b32 s55, s55, s52
    s_bfe_u32 s56, s38, 196620
    s_bfe_u32 s52, s38, 196623
    s_lshl_b32 s52, s52, 16
    s_or_b32 s56, s56, s52
    s_bfe_u32 s57, s38, 196626
    s_bfe_u32 s52, s38, 196629
    s_lshl_b32 s52, s52, 16
    s_or_b32 s57, s57, s52
    s_cmp_eq_u32 s41, 0
    s_cselect_b32 s58, 0, 512
    s_cselect_b32 s60, 512, 0
    s_add_u32 s59, s58, 256
    s_add_u32 s60, s60, 1024
    s_add_u32 s61, s60, 256
    s_lshl_b32 s52, s40, 14
    s_lshl_b32 s53, s43, 10
    s_add_u32 s52, s52, s53
    s_add_u32 s52, s52, 1052672
    v_add_u32 v20, s52, v2
    v_add_u32 v21, 0x2000, v20
    v_and_b32 v17, 3, v1
    v_mul_u32_u24 v17, 4640, v17
    v_lshrrev_b32 v16, 2, v1
    v_lshl_add_u32 v17, v16, 4, v17
    s_lshl_b32 s52, s43, 8
    s_add_u32 s52, s52, 90112
    v_add_u32 v24, s52, v17
    s_lshl_b32 s52, s43, 6
    v_add_u32 v25, s52, v1
    v_lshlrev_b32 v26, 3, v25
    v_add_u32 v26, 8192, v26
    v_and_b32 v16, 3, v1
    v_mul_u32_u24 v16, 264, v16
    v_bfe_u32 v17, v1, 2, 2
    v_lshl_add_u32 v16, v17, 6, v16
    v_lshrrev_b32 v17, 4, v25
    v_lshl_add_u32 v27, v17, 2, v16
    v_lshlrev_b32 v28, 1, v25
    v_add_u32 v28, 90112, v28
    s_lshl_b32 s52, s40, 3
    v_lshl_add_u32 v29, v25, 10, s52
    s_lshl_b32 s52, s58, 3
    v_add_u32 v30, s52, v26
    s_lshl_b32 s52, s59, 3
    v_add_u32 v31, s52, v26
    s_lshl_b32 s52, s60, 3
    v_add_u32 v32, s52, v26
    s_lshl_b32 s52, s61, 3
    v_add_u32 v33, s52, v26
    v_mov_b32 v88, s54
    v_mov_b32 v89, s55
    v_mov_b32 v90, s56
    v_mov_b32 v91, s57
    v_mov_b32 v92, s54
    v_mov_b32 v93, s55
    v_mov_b32 v94, s56
    v_mov_b32 v95, s57
    s_cmp_eq_u32 s41, 1
    s_cselect_b32 s52, 1, s43
    s_cmp_eq_u32 s52, 0
    s_cbranch_scc1 L_rpoll
    s_waitcnt lgkmcnt(0)
    s_mov_b32 s53, 0
spin_13:
    ds_read_b64 v[18:19], v61 offset:96
    s_waitcnt lgkmcnt(0)
    v_readfirstlane_b32 s52, v18
    s_add_u32 s53, s53, 1
    s_cmp_eq_u32 s52, 1
    s_cbranch_scc1 spun_14
    s_cmp_lt_u32 s53, 3200000
    s_sleep 1
    s_cbranch_scc1 spin_13
spun_14:
    v_readfirstlane_b32 s50, v19
L_xt1:
    s_sleep 2
L_xt2:
    s_mov_b32 s53, 0
L_x1:
    global_load_dwordx4 v[64:67], v20, s[36:37] offset:-4096 sc1
    global_load_dwordx4 v[68:71], v20, s[36:37] offset:-2048 sc1
    global_load_dwordx4 v[72:75], v20, s[36:37] offset:0 sc1
    global_load_dwordx4 v[76:79], v20, s[36:37] offset:2048 sc1
    global_load_dwordx4 v[80:83], v21, s[36:37] offset:-4096 sc1
    global_load_dwordx4 v[84:87], v21, s[36:37] offset:-2048 sc1
    s_cmp_eq_u32 s41, 1
    s_cbranch_scc1 L_x1b
    global_load_dwordx4 v[88:91], v21, s[36:37] offset:0 sc1
    global_load_dwordx4 v[92:95], v21, s[36:37] offset:2048 sc1
L_x1b:
    s_add_u32 s53, s53, 1
    s_waitcnt vmcnt(5)
    v_xor_b32 v112, s54, v64
    v_xor_b32 v113, s55, v65
    v_xor_b32 v114, s56, v66
    v_xor_b32 v115, s57, v67
    ds_write_b128 v24, v[112:115] offset:0
    v_or3_b32 v16, v112, v113, v114
    v_mov_b32 v17, v115
    s_waitcnt vmcnt(4)
    v_xor_b32 v116, s54, v68
    v_xor_b32 v117, s55, v69
    v_xor_b32 v118, s56, v70
    v_xor_b32 v119, s57, v71
    ds_write_b128 v24, v[116:119] offset:512
    v_or3_b32 v16, v16, v116, v117
    v_or3_b32 v17, v17, v118, v119
    s_waitcnt vmcnt(3)
    v_xor_b32 v112, s54, v72
    v_xor_b32 v113, s55, v73
    v_xor_b32 v114, s56, v74
    v_xor_b32 v115, s57, v75
    ds_write_b128 v24, v[112:115] offset:1024
    v_or3_b32 v16, v16, v112, v113
    v_or3_b32 v17, v17, v114, v115
    s_waitcnt vmcnt(2)
    v_xor_b32 v116, s54, v76
    v_xor_b32 v117, s55, v77
    v_xor_b32 v118, s56, v78
    v_xor_b32 v119, s57, v79
    ds_write_b128 v24, v[116:119] offset:1536
    v_or3_b32 v16, v16, v116, v117
    v_or3_b32 v17, v17, v118, v119
    s_waitcnt vmcnt(1)
    v_xor_b32 v112, s54, v80
    v_xor_b32 v113, s55, v81
    v_xor_b32 v114, s56, v82
    v_xor_b32 v115, s57, v83
    ds_write_b128 v24, v[112:115] offset:2048
    v_or3_b32 v16, v16, v112, v113
    v_or3_b32 v17, v17, v114, v115
    s_waitcnt vmcnt(0)
    v_xor_b32 v116, s54, v84
    v_xor_b32 v117, s55, v85
    v_xor_b32 v118, s56, v86
    v_xor_b32 v119, s57, v87
    ds_write_b128 v24, v[116:119] offset:2560
    v_or3_b32 v16, v16, v116, v117
    v_or3_b32 v17, v17, v118, v119
    s_waitcnt vmcnt(0)
    v_xor_b32 v112, s54, v88
    v_xor_b32 v113, s55, v89
    v_xor_b32 v114, s56, v90
    v_xor_b32 v115, s57, v91
    ds_write_b128 v24, v[112:115] offset:3072
    v_or3_b32 v16, v16, v112, v113
    v_or3_b32 v17, v17, v114, v115
    s_waitcnt vmcnt(0)
    v_xor_b32 v116, s54, v92
    v_xor_b32 v117, s55, v93
    v_xor_b32 v118, s56, v94
    v_xor_b32 v119, s57, v95
    ds_write_b128 v24, v[116:119] offset:3584
    v_or3_b32 v16, v16, v116, v117
    v_or3_b32 v17, v17, v118, v119
    v_or_b32 v16, v16, v17
    v_and_b32 v16, 0x70007, v16
    v_cmp_ne_u32 vcc, 0, v16
    s_cbranch_vccz L_x2
    s_cmp_lt_u32 s53, 200000
    s_cbranch_scc1 L_x1
L_x2:
    v_mov_b32 v16, 1
    ds_write_b8 v60, v16 offset:20
    s_mov_b32 s53, 0
L_x3:
    global_load_dwordx2 v[96:97], v30, s[36:37] offset:0 sc1
    global_load_dwordx2 v[98:99], v30, s[36:37] offset:1024 sc1
    global_load_dwordx2 v[100:101], v31, s[36:37] offset:0 sc1
    global_load_dwordx2 v[102:103], v31, s[36:37] offset:1024 sc1
    global_load_dwordx2 v[104:105], v32, s[36:37] offset:0 sc1
    global_load_dwordx2 v[106:107], v32, s[36:37] offset:1024 sc1
    global_load_dwordx2 v[108:109], v33, s[36:37] offset:0 sc1
    global_load_dwordx2 v[110:111], v33, s[36:37] offset:1024 sc1
    s_waitcnt vmcnt(7)
    v_xor_b32 v96, s46, v96
    v_xor_b32 v97, s47, v97
    v_or3_b32 v16, 0, v96, v97
    s_waitcnt vmcnt(6)
    v_xor_b32 v98, s46, v98
    v_xor_b32 v99, s47, v99
    v_or3_b32 v16, v16, v98, v99
    s_waitcnt vmcnt(5)
    v_xor_b32 v100, s46, v100
    v_xor_b32 v101, s47, v101
    v_or3_b32 v16, v16, v100, v101
    s_waitcnt vmcnt(4)
    v_xor_b32 v102, s46, v102
    v_xor_b32 v103, s47, v103
    v_or3_b32 v16, v16, v102, v103
    s_waitcnt vmcnt(3)
    v_xor_b32 v104, s46, v104
    v_xor_b32 v105, s47, v105
    v_or3_b32 v16, v16, v104, v105
    s_waitcnt vmcnt(2)
    v_xor_b32 v106, s46, v106
    v_xor_b32 v107, s47, v107
    v_or3_b32 v16, v16, v106, v107
    s_waitcnt vmcnt(1)
    v_xor_b32 v108, s46, v108
    v_xor_b32 v109, s47, v109
    v_or3_b32 v16, v16, v108, v109
    s_waitcnt vmcnt(0)
    v_xor_b32 v110, s46, v110
    v_xor_b32 v111, s47, v111
    v_or3_b32 v16, v16, v110, v111
    v_and_b32 v16, 0xffff, v16
    v_cmp_ne_u32 vcc, 0, v16
    s_cbranch_vccz L_x4
    s_add_u32 s53, s53, 1
    s_cmp_lt_u32 s53, 200000
    s_cbranch_scc1 L_x3
L_x4:
    s_waitcnt lgkmcnt(0)
    s_mov_b32 s53, 0
spin_15:
    ds_read_b32 v18, v61 offset:32
    s_waitcnt lgkmcnt(0)
    v_readfirstlane_b32 s52, v18
    s_add_u32 s53, s53, 1
    s_cmp_eq_u32 s52, 16843009
    s_cbranch_scc1 spun_16
    s_cmp_lt_u32 s53, 3200000
    s_sleep 1
    s_cbranch_scc1 spin_15
spun_16:
    ds_read_b128 v[36:39], v61 offset:80
    s_lshl_b32 s52, s58, 1
    v_add_u32 v30, s52, v28
    s_lshl_b32 s52, s58, 10
    s_add_u32 s64, s32, s52
    s_addc_u32 s65, s33, 0
    s_sub_u32 s63, s50, s58
    ds_read_b32 v112, v27 offset:0
    ds_read_u16_d16 v116, v30 offset:0
    ds_read_b32 v113, v27 offset:15232
    ds_read_u16_d16 v117, v30 offset:4640
    ds_read_b32 v114, v27 offset:30464
    ds_read_u16_d16 v118, v30 offset:9280
    ds_read_b32 v115, v27 offset:45696
    ds_read_u16_d16 v119, v30 offset:13920
    ds_read_b32 v120, v27 offset:32
    ds_read_u16_d16 v124, v30 offset:256
    ds_read_b32 v121, v27 offset:15264
    ds_read_u16_d16 v125, v30 offset:4896
    ds_read_b32 v122, v27 offset:30496
    ds_read_u16_d16 v126, v30 offset:9536
    ds_read_b32 v123, v27 offset:45728
    ds_read_u16_d16 v127, v30 offset:14176
    s_waitcnt lgkmcnt(14)
    v_fma_mix_f32 v116, v116, v97, v96 op_sel_hi:[1,0,0]
    s_waitcnt lgkmcnt(12)
    v_fma_mix_f32 v117, v117, v97, v96 op_sel_hi:[1,0,0]
    s_waitcnt lgkmcnt(10)
    v_fma_mix_f32 v118, v118, v97, v96 op_sel_hi:[1,0,0]
    s_waitcnt lgkmcnt(8)
    v_fma_mix_f32 v119, v119, v97, v96 op_sel_hi:[1,0,0]
    v_cmp_ne_u32 vcc, s63, v25
    v_fma_f32 v112, v112, v36, v116
    v_fma_f32 v113, v113, v37, v117
    v_fma_f32 v114, v114, v38, v118
    v_fma_f32 v115, v115, v39, v119
    v_cvt_pk_bf16_f32 v116, v112, v113
    v_cvt_pk_bf16_f32 v117, v114, v115
    s_mov_b64 exec, vcc
    global_store_dwordx2 v29, v[116:117], s[64:65]
    s_not_b64 exec, exec
    s_cbranch_execz nosave_17
    v_mov_b32 v16, 1
    ds_write_b128 v61, v[112:115] offset:64
    ds_write_b32 v61, v16 offset:48
nosave_17:
    s_mov_b64 exec, -1
    s_waitcnt lgkmcnt(8)
    v_fma_mix_f32 v124, v124, v99, v98 op_sel_hi:[1,0,0]
    s_waitcnt lgkmcnt(6)
    v_fma_mix_f32 v125, v125, v99, v98 op_sel_hi:[1,0,0]
    s_waitcnt lgkmcnt(4)
    v_fma_mix_f32 v126, v126, v99, v98 op_sel_hi:[1,0,0]
    s_waitcnt lgkmcnt(2)
    v_fma_mix_f32 v127, v127, v99, v98 op_sel_hi:[1,0,0]
    s_sub_u32 s63, s63, 128
    v_cmp_ne_u32 vcc, s63, v25
    v_fma_f32 v120, v120, v36, v124
    v_fma_f32 v121, v121, v37, v125
    v_fma_f32 v122, v122, v38, v126
    v_fma_f32 v123, v123, v39, v127
    v_cvt_pk_bf16_f32 v124, v120, v121
    v_cvt_pk_bf16_f32 v125, v122, v123
    s_add_u32 s64, s64, 0x20000
    s_addc_u32 s65, s65, 0
    s_mov_b64 exec, vcc
    global_store_dwordx2 v29, v[124:125], s[64:65]
    s_not_b64 exec, exec
    s_cbranch_execz nosave_18
    v_mov_b32 v16, 1
    ds_write_b128 v61, v[120:123] offset:64
    ds_write_b32 v61, v16 offset:48
nosave_18:
    s_mov_b64 exec, -1
    s_waitcnt lgkmcnt(0)
    s_mov_b32 s53, 0
spin_19:
    ds_read_b32 v18, v61 offset:36
    s_waitcnt lgkmcnt(0)
    v_readfirstlane_b32 s52, v18
    s_add_u32 s53, s53, 1
    s_cmp_eq_u32 s52, 16843009
    s_cbranch_scc1 spun_20
    s_cmp_lt_u32 s53, 3200000
    s_sleep 1
    s_cbranch_scc1 spin_19
spun_20:
    s_lshl_b32 s52, s59, 1
    v_add_u32 v30, s52, v28
    s_lshl_b32 s52, s59, 10
    s_add_u32 s64, s32, s52
    s_addc_u32 s65, s33, 0
    s_sub_u32 s63, s50, s59
    ds_read_b32 v112, v27 offset:1056
    ds_read_u16_d16 v116, v30 offset:0
    ds_read_b32 v113, v27 offset:16288
    ds_read_u16_d16 v117, v30 offset:4640
    ds_read_b32 v114, v27 offset:31520
    ds_read_u16_d16 v118, v30 offset:9280
    ds_read_b32 v115, v27 offset:46752
    ds_read_u16_d16 v119, v30 offset:13920
    ds_read_b32 v120, v27 offset:1088
    ds_read_u16_d16 v124, v30 offset:256
    ds_read_b32 v121, v27 offset:16320
    ds_read_u16_d16 v125, v30 offset:4896
    ds_read_b32 v122, v27 offset:31552
    ds_read_u16_d16 v126, v30 offset:9536
    ds_read_b32 v123, v27 offset:46784
    ds_read_u16_d16 v127, v30 offset:14176
    s_waitcnt lgkmcnt(14)
    v_fma_mix_f32 v116, v116, v101, v100 op_sel_hi:[1,0,0]
    s_waitcnt lgkmcnt(12)
    v_fma_mix_f32 v117, v117, v101, v100 op_sel_hi:[1,0,0]
    s_waitcnt lgkmcnt(10)
    v_fma_mix_f32 v118, v118, v101, v100 op_sel_hi:[1,0,0]
    s_waitcnt lgkmcnt(8)
    v_fma_mix_f32 v119, v119, v101, v100 op_sel_hi:[1,0,0]
    v_cmp_ne_u32 vcc, s63, v25
    v_fma_f32 v112, v112, v36, v116
    v_fma_f32 v113, v113, v37, v117
    v_fma_f32 v114, v114, v38, v118
    v_fma_f32 v115, v115, v39, v119
    v_cvt_pk_bf16_f32 v116, v112, v113
    v_cvt_pk_bf16_f32 v117, v114, v115
    s_mov_b64 exec, vcc
    global_store_dwordx2 v29, v[116:117], s[64:65]
    s_not_b64 exec, exec
    s_cbranch_execz nosave_21
    v_mov_b32 v16, 1
    ds_write_b128 v61, v[112:115] offset:64
    ds_write_b32 v61, v16 offset:48
nosave_21:
    s_mov_b64 exec, -1
    s_waitcnt lgkmcnt(8)
    v_fma_mix_f32 v124, v124, v103, v102 op_sel_hi:[1,0,0]
    s_waitcnt lgkmcnt(6)
    v_fma_mix_f32 v125, v125, v103, v102 op_sel_hi:[1,0,0]
    s_waitcnt lgkmcnt(4)
    v_fma_mix_f32 v126, v126, v103, v102 op_sel_hi:[1,0,0]
    s_waitcnt lgkmcnt(2)
    v_fma_mix_f32 v127, v127, v103, v102 op_sel_hi:[1,0,0]
    s_sub_u32 s63, s63, 128
    v_cmp_ne_u32 vcc, s63, v25
    v_fma_f32 v120, v120, v36, v124
    v_fma_f32 v121, v121, v37, v125
    v_fma_f32 v122, v122, v38, v126
    v_fma_f32 v123, v123, v39, v127
    v_cvt_pk_bf16_f32 v124, v120, v121
    v_cvt_pk_bf16_f32 v125, v122, v123
    s_add_u32 s64, s64, 0x20000
    s_addc_u32 s65, s65, 0
    s_mov_b64 exec, vcc
    global_store_dwordx2 v29, v[124:125], s[64:65]
    s_not_b64 exec, exec
    s_cbranch_execz nosave_22
    v_mov_b32 v16, 1
    ds_write_b128 v61, v[120:123] offset:64
    ds_write_b32 v61, v16 offset:48
nosave_22:
    s_mov_b64 exec, -1
    s_waitcnt lgkmcnt(0)
    s_mov_b32 s53, 0
spin_23:
    ds_read_b32 v18, v61 offset:40
    s_waitcnt lgkmcnt(0)
    v_readfirstlane_b32 s52, v18
    s_add_u32 s53, s53, 1
    s_cmp_eq_u32 s52, 16843009
    s_cbranch_scc1 spun_24
    s_cmp_lt_u32 s53, 3200000
    s_sleep 1
    s_cbranch_scc1 spin_23
spun_24:
    s_lshl_b32 s52, s60, 1
    v_add_u32 v30, s52, v28
    s_lshl_b32 s52, s60, 10
    s_add_u32 s64, s32, s52
    s_addc_u32 s65, s33, 0
    s_sub_u32 s63, s50, s60
    ds_read_b32 v112, v27 offset:2112
    ds_read_u16_d16 v116, v30 offset:0
    ds_read_b32 v113, v27 offset:17344
    ds_read_u16_d16 v117, v30 offset:4640
    ds_read_b32 v114, v27 offset:32576
    ds_read_u16_d16 v118, v30 offset:9280
    ds_read_b32 v115, v27 offset:47808
    ds_read_u16_d16 v119, v30 offset:13920
    ds_read_b32 v120, v27 offset:2144
    ds_read_u16_d16 v124, v30 offset:256
    ds_read_b32 v121, v27 offset:17376
    ds_read_u16_d16 v125, v30 offset:4896
    ds_read_b32 v122, v27 offset:32608
    ds_read_u16_d16 v126, v30 offset:9536
    ds_read_b32 v123, v27 offset:47840
    ds_read_u16_d16 v127, v30 offset:14176
    s_waitcnt lgkmcnt(14)
    v_fma_mix_f32 v116, v116, v105, v104 op_sel_hi:[1,0,0]
    s_waitcnt lgkmcnt(12)
    v_fma_mix_f32 v117, v117, v105, v104 op_sel_hi:[1,0,0]
    s_waitcnt lgkmcnt(10)
    v_fma_mix_f32 v118, v118, v105, v104 op_sel_hi:[1,0,0]
    s_waitcnt lgkmcnt(8)
    v_fma_mix_f32 v119, v119, v105, v104 op_sel_hi:[1,0,0]
    v_cmp_ne_u32 vcc, s63, v25
    v_fma_f32 v112, v112, v36, v116
    v_fma_f32 v113, v113, v37, v117
    v_fma_f32 v114, v114, v38, v118
    v_fma_f32 v115, v115, v39, v119
    v_cvt_pk_bf16_f32 v116, v112, v113
    v_cvt_pk_bf16_f32 v117, v114, v115
    s_mov_b64 exec, vcc
    global_store_dwordx2 v29, v[116:117], s[64:65]
    s_not_b64 exec, exec
    s_cbranch_execz nosave_25
    v_mov_b32 v16, 1
    ds_write_b128 v61, v[112:115] offset:64
    ds_write_b32 v61, v16 offset:48
nosave_25:
    s_mov_b64 exec, -1
    s_waitcnt lgkmcnt(8)
    v_fma_mix_f32 v124, v124, v107, v106 op_sel_hi:[1,0,0]
    s_waitcnt lgkmcnt(6)
    v_fma_mix_f32 v125, v125, v107, v106 op_sel_hi:[1,0,0]
    s_waitcnt lgkmcnt(4)
    v_fma_mix_f32 v126, v126, v107, v106 op_sel_hi:[1,0,0]
    s_waitcnt lgkmcnt(2)
    v_fma_mix_f32 v127, v127, v107, v106 op_sel_hi:[1,0,0]
    s_sub_u32 s63, s63, 128
    v_cmp_ne_u32 vcc, s63, v25
    v_fma_f32 v120, v120, v36, v124
    v_fma_f32 v121, v121, v37, v125
    v_fma_f32 v122, v122, v38, v126
    v_fma_f32 v123, v123, v39, v127
    v_cvt_pk_bf16_f32 v124, v120, v121
    v_cvt_pk_bf16_f32 v125, v122, v123
    s_add_u32 s64, s64, 0x20000
    s_addc_u32 s65, s65, 0
    s_mov_b64 exec, vcc
    global_store_dwordx2 v29, v[124:125], s[64:65]
    s_not_b64 exec, exec
    s_cbranch_execz nosave_26
    v_mov_b32 v16, 1
    ds_write_b128 v61, v[120:123] offset:64
    ds_write_b32 v61, v16 offset:48
nosave_26:
    s_mov_b64 exec, -1
    s_waitcnt lgkmcnt(0)
    s_mov_b32 s53, 0
spin_27:
    ds_read_b32 v18, v61 offset:44
    s_waitcnt lgkmcnt(0)
    v_readfirstlane_b32 s52, v18
    s_add_u32 s53, s53, 1
    s_cmp_eq_u32 s52, 16843009
    s_cbranch_scc1 spun_28
    s_cmp_lt_u32 s53, 3200000
    s_sleep 1
    s_cbranch_scc1 spin_27
spun_28:
    s_lshl_b32 s52, s61, 1
    v_add_u32 v30, s52, v28
    s_lshl_b32 s52, s61, 10
    s_add_u32 s64, s32, s52
    s_addc_u32 s65, s33, 0
    s_sub_u32 s63, s50, s61
    ds_read_b32 v112, v27 offset:3168
    ds_read_u16_d16 v116, v30 offset:0
    ds_read_b32 v113, v27 offset:18400
    ds_read_u16_d16 v117, v30 offset:4640
    ds_read_b32 v114, v27 offset:33632
    ds_read_u16_d16 v118, v30 offset:9280
    ds_read_b32 v115, v27 offset:48864
    ds_read_u16_d16 v119, v30 offset:13920
    ds_read_b32 v120, v27 offset:3200
    ds_read_u16_d16 v124, v30 offset:256
    ds_read_b32 v121, v27 offset:18432
    ds_read_u16_d16 v125, v30 offset:4896
    ds_read_b32 v122, v27 offset:33664
    ds_read_u16_d16 v126, v30 offset:9536
    ds_read_b32 v123, v27 offset:48896
    ds_read_u16_d16 v127, v30 offset:14176
    s_waitcnt lgkmcnt(14)
    v_fma_mix_f32 v116, v116, v109, v108 op_sel_hi:[1,0,0]
    s_waitcnt lgkmcnt(12)
    v_fma_mix_f32 v117, v117, v109, v108 op_sel_hi:[1,0,0]
    s_waitcnt lgkmcnt(10)
    v_fma_mix_f32 v118, v118, v109, v108 op_sel_hi:[1,0,0]
    s_waitcnt lgkmcnt(8)
    v_fma_mix_f32 v119, v119, v109, v108 op_sel_hi:[1,0,0]
    v_cmp_ne_u32 vcc, s63, v25
    v_fma_f32 v112, v112, v36, v116
    v_fma_f32 v113, v113, v37, v117
    v_fma_f32 v114, v114, v38, v118
    v_fma_f32 v115, v115, v39, v119
    v_cvt_pk_bf16_f32 v116, v112, v113
    v_cvt_pk_bf16_f32 v117, v114, v115
    s_mov_b64 exec, vcc
    global_store_dwordx2 v29, v[116:117], s[64:65]
    s_not_b64 exec, exec
    s_cbranch_execz nosave_29
    v_mov_b32 v16, 1
    ds_write_b128 v61, v[112:115] offset:64
    ds_write_b32 v61, v16 offset:48
nosave_29:
    s_mov_b64 exec, -1
    s_waitcnt lgkmcnt(8)
    v_fma_mix_f32 v124, v124, v111, v110 op_sel_hi:[1,0,0]
    s_waitcnt lgkmcnt(6)
    v_fma_mix_f32 v125, v125, v111, v110 op_sel_hi:[1,0,0]
    s_waitcnt lgkmcnt(4)
    v_fma_mix_f32 v126, v126, v111, v110 op_sel_hi:[1,0,0]
    s_waitcnt lgkmcnt(2)
    v_fma_mix_f32 v127, v127, v111, v110 op_sel_hi:[1,0,0]
    s_sub_u32 s63, s63, 128
    v_cmp_ne_u32 vcc, s63, v25
    v_fma_f32 v120, v120, v36, v124
    v_fma_f32 v121, v121, v37, v125
    v_fma_f32 v122, v122, v38, v126
    v_fma_f32 v123, v123, v39, v127
    v_cvt_pk_bf16_f32 v124, v120, v121
    v_cvt_pk_bf16_f32 v125, v122, v123
    s_add_u32 s64, s64, 0x20000
    s_addc_u32 s65, s65, 0
    s_mov_b64 exec, vcc
    global_store_dwordx2 v29, v[124:125], s[64:65]
    s_not_b64 exec, exec
    s_cbranch_execz nosave_30
    v_mov_b32 v16, 1
    ds_write_b128 v61, v[120:123] offset:64
    ds_write_b32 v61, v16 offset:48
nosave_30:
    s_mov_b64 exec, -1
    s_endpgm
.p2align 6
L_conv:
    s_lshl_b32 s54, s40, 2
    s_add_u32 s54, s54, s39
    s_lshl_b32 s58, s54, 8
    v_lshl_add_u32 v36, v1, 2, s58
    s_lshr_b32 s58, s54, 1
    s_lshl_b32 s58, s58, 2
    s_waitcnt lgkmcnt(0)
    global_load_dword v4, v36, s[6:7]
    global_load_dword v5, v36, s[8:9]
    global_load_dword v6, v36, s[10:11]
    global_load_dword v7, v36, s[12:13]
    global_load_dword v8, v36, s[14:15]
    global_load_dword v9, v36, s[16:17]
    s_load_dword s55, s[18:19], s58
    s_load_dword s56, s[20:21], s58
    v_add_u32 v247, L_tab-L_pc, v2
    s_mul_i32 s57, s39, 7168
    s_add_u32 s57, s57, 60928
    s_mul_i32 s59, s39, 15232
    s_mov_b32 m0, s59
    v_and_b32 v42, 31, v1
    v_lshrrev_b32 v43, 5, v1
    v_mul_u32_u24 v248, 272, v42
    v_lshl_add_u32 v248, v43, 4, v248
    v_add_u32 v248, s59, v248
    v_mov_b32 v40, 0
    v_mov_b32 v41, 0
    v_mov_b32 v42, 0
    v_mov_b32 v43, 0
    v_add_u32 v39, s57, v2
    ds_write_b128 v39, v[40:43]
    ds_write_b128 v39, v[40:43] offset:768
    s_mul_i32 s61, s39, 4640
    s_add_u32 s61, s61, 89600
    v_lshl_add_u32 v39, v1, 3, s61
    ds_write_b64 v39, v[40:41]
    v_lshrrev_b32 v38, 4, v1
    v_mul_u32_u24 v38, 1216, v38
    v_and_b32 v39, 15, v1
    v_lshl_add_u32 v38, v39, 3, v38
    v_cmp_lt_u32 vcc, 8, v39
    s_add_u32 s59, s57, 1792
    v_add_u32 v38, s59, v38
    v_add_u32 v39, 1032, v38
    v_cndmask_b32 v38, v38, v39, vcc
    ds_write_b64 v38, v[40:41]
    v_cmp_eq_u32 vcc, 0, v1
    s_barrier
    s_waitcnt lgkmcnt(0)
    s_lshl_b32 s59, s55, 16
    s_and_b32 s55, s55, 0xffff0000
    s_lshl_b32 s60, s56, 16
    s_and_b32 s56, s56, 0xffff0000
    s_bitcmp1_b32 s54, 0
    s_cselect_b32 s55, s55, s59
    s_cselect_b32 s56, s56, s60
    v_mov_b32 v82, s55
    v_mul_f32 v82, 0x3fb8aa3b, v82
    v_exp_f32 v82, v82
    v_mov_b32 v85, 0x3c00
    v_cvt_pk_bf16_f32 v82, v82, v82
    v_lshlrev_b32 v82, 16, v82
    v_mul_f32 v83, 0x3fb8aa3b, v82
    v_mul_f32 v84, 0x3e22f983, v82
    v_add_f32 v10, 1.0, s56
    v_and_b32 v86, 0x7fffffff, v10
    v_cndmask_b32 v10, 0, v10, vcc
    v_add_u32 v224, 4096, v247
    s_cmp_lg_u32 s41, 1
    s_cbranch_scc1 L_wa
    s_cmp_ge_u32 s40, 112
    s_cbranch_scc1 L_wa
    s_bitcmp0_b32 s39, 0
    s_cselect_b32 s62, s26, s28
    s_cselect_b32 s63, s27, s29
    s_lshr_b32 s59, s40, 4
    s_lshl_b32 s59, s59, 9
    s_and_b32 s60, s40, 15
    s_lshr_b32 s64, s39, 1
    s_lshl_b32 s64, s64, 4
    s_add_u32 s60, s60, s64
    s_mul_i32 s60, s60, 57344
    s_add_u32 s59, s59, s60
    v_lshrrev_b32 v38, 2, v1
    v_mul_u32_u24 v38, 3584, v38
    v_and_b32 v39, 3, v1
    v_lshl_add_u32 v38, v39, 7, v38
    v_add_u32 v38, s59, v38
    global_load_dword v225, v38, s[62:63]
    s_cmp_lg_u32 s41, 1
    s_cbranch_scc1 L_wa
    s_cmp_ge_u32 s40, 112
    s_cbranch_scc1 L_wa
    s_waitcnt vmcnt(1)
    s_branch L_wb
L_wa:
    s_waitcnt vmcnt(0)
L_wb:
    v_lshlrev_b32 v44, 16, v6
    v_lshlrev_b32 v45, 16, v7
    v_lshlrev_b32 v46, 16, v8
    v_lshlrev_b32 v47, 16, v9
    v_lshlrev_b32 v36, 16, v4
    v_lshlrev_b32 v37, 16, v5
    v_pk_mul_f32 v[62:63], v[44:45], v[46:47] op_sel:[0,0] op_sel_hi:[1,0]
    v_pk_fma_f32 v[40:41], v[44:45], v[46:47], v[62:63] op_sel:[1,1,0] op_sel_hi:[0,1,1] neg_lo:[1,0,0]
    v_mul_f32 v36, v36, v83
    v_mul_f32 v37, v37, v84
    v_and_b32 v44, 0xffff0000, v6
    v_and_b32 v45, 0xffff0000, v7
    v_and_b32 v46, 0xffff0000, v8
    v_and_b32 v47, 0xffff0000, v9
    v_and_b32 v38, 0xffff0000, v4
    v_and_b32 v39, 0xffff0000, v5
    v_pk_mul_f32 v[62:63], v[44:45], v[46:47] op_sel:[0,0] op_sel_hi:[1,0]
    v_pk_fma_f32 v[42:43], v[44:45], v[46:47], v[62:63] op_sel:[1,1,0] op_sel_hi:[0,1,1] neg_lo:[1,0,0]
    v_mul_f32 v38, v38, v83
    v_mul_f32 v39, v39, v84
    v_add_f32 v87, |v40|, |v41|
    v_add_f32 v70, |v42|, |v43|
    v_add_f32 v87, v87, v70
    v_mul_f32 v70, 0x41000000, v37
    v_mul_f32 v72, 0x41000000, v36
    v_add_f32_dpp v87, v87, v87 row_shr:1 row_mask:0xf bank_mask:0xf bound_ctrl:0
    v_fract_f32 v70, v70
    v_exp_f32 v72, v72
    v_cos_f32 v56, v70
    v_sin_f32 v57, v70
    v_add_f32_dpp v87, v87, v87 row_shr:2 row_mask:0xf bank_mask:0xf bound_ctrl:0
    v_pk_mul_f32 v[56:57], v[56:57], v[72:73] op_sel_hi:[1,0]
    s_nop 0
    v_add_f32_dpp v87, v87, v87 row_shr:4 row_mask:0xf bank_mask:0xf bound_ctrl:0
    v_fract_f32 v70, v37
    v_exp_f32 v72, v36
    v_cos_f32 v52, v70
    v_sin_f32 v53, v70
    v_add_f32_dpp v87, v87, v87 row_shr:8 row_mask:0xf bank_mask:0xf bound_ctrl:0
    v_pk_mul_f32 v[52:53], v[52:53], v[72:73] op_sel_hi:[1,0]
    s_nop 0
    v_add_f32_dpp v87, v87, v87 row_bcast:15 row_mask:0xa bank_mask:0xf
    v_mul_f32 v70, 0x43800000, v37
    v_mul_f32 v72, 0x43800000, v36
    v_add_f32_dpp v87, v87, v87 row_bcast:31 row_mask:0xc bank_mask:0xf
    v_fract_f32 v70, v70
    v_exp_f32 v72, v72
    v_cos_f32 v58, v70
    v_sin_f32 v59, v70
    s_nop 0
    v_pk_mul_f32 v[58:59], v[58:59], v[72:73] op_sel_hi:[1,0]
    v_readlane_b32 s59, v87, 63
    s_nop 1
    v_fma_f32 v70, v82, s59, v86
    v_frexp_exp_i32_f32 v70, v70
    v_sub_u32 v71, 14, v70
    v_subrev_u32 v70, 14, v70
    v_ldexp_f32 v72, v82, v71
    v_ldexp_f32 v10, v10, v71
    v_ldexp_f32 v70, 1.0, v70
    s_lshl_b32 s60, s39, 2
    s_add_u32 s60, s60, 141136
    v_mov_b32 v71, s60
    v_pk_mul_f32 v[40:41], v[40:41], v[72:73] op_sel_hi:[1,0]
    v_pk_mul_f32 v[42:43], v[42:43], v[72:73] op_sel_hi:[1,0]
    s_mov_b64 exec, 1
    ds_write_b32 v71, v70
    s_mov_b64 exec, -1
    v_pk_mul_f32 v[62:63], v[56:57], v[56:57] op_sel:[0,0] op_sel_hi:[1,0]
    v_pk_fma_f32 v[68:69], v[56:57], v[56:57], v[62:63] op_sel:[1,1,0] op_sel_hi:[0,1,1] neg_lo:[1,0,0]
    v_pk_mul_f32 v[62:63], v[68:69], v[56:57] op_sel:[0,0] op_sel_hi:[1,0]
    v_pk_fma_f32 v[60:61], v[68:69], v[56:57], v[62:63] op_sel:[1,1,0] op_sel_hi:[0,1,1] neg_lo:[1,0,0]
    v_pk_mul_f32 v[62:63], v[68:69], v[68:69] op_sel:[0,0] op_sel_hi:[1,0]
    v_pk_fma_f32 v[66:67], v[68:69], v[68:69], v[62:63] op_sel:[1,1,0] op_sel_hi:[0,1,1] neg_lo:[1,0,0]
    v_cvt_pk_f16_f32 v74, v56, v57
    v_cvt_pk_f16_f32 v75, v68, v69
    v_cvt_pk_f16_f32 v76, v60, v61
    ds_write_addtid_b32 v85 offset:6528
    ds_write_addtid_b32 v74 offset:6800
    ds_write_addtid_b32 v75 offset:7072
    ds_write_addtid_b32 v76 offset:7344
    v_cvt_pk_f16_f32 v88, v66, v67
    v_pk_mul_f16 v77, v88, v74 op_sel:[0,0] op_sel_hi:[1,0]
    v_pk_fma_f16 v89, v88, v74, v77 op_sel:[1,1,0] op_sel_hi:[0,1,1] neg_lo:[1,0,0]
    v_pk_mul_f16 v77, v88, v75 op_sel:[0,0] op_sel_hi:[1,0]
    v_pk_fma_f16 v90, v88, v75, v77 op_sel:[1,1,0] op_sel_hi:[0,1,1] neg_lo:[1,0,0]
    v_pk_mul_f16 v77, v88, v76 op_sel:[0,0] op_sel_hi:[1,0]
    v_pk_fma_f16 v91, v88, v76, v77 op_sel:[1,1,0] op_sel_hi:[0,1,1] neg_lo:[1,0,0]
    ds_write_addtid_b32 v88 offset:7616
    ds_write_addtid_b32 v89 offset:7888
    ds_write_addtid_b32 v90 offset:8160
    ds_write_addtid_b32 v91 offset:8432
    v_pk_mul_f32 v[62:63], v[66:67], v[66:67] op_sel:[0,0] op_sel_hi:[1,0]
    v_pk_fma_f32 v[60:61], v[66:67], v[66:67], v[62:63] op_sel:[1,1,0] op_sel_hi:[0,1,1] neg_lo:[1,0,0]
    v_cvt_pk_f16_f32 v92, v60, v61
    v_pk_mul_f16 v77, v92, v74 op_sel:[0,0] op_sel_hi:[1,0]
    v_pk_fma_f16 v93, v92, v74, v77 op_sel:[1,1,0] op_sel_hi:[0,1,1] neg_lo:[1,0,0]
    v_pk_mul_f16 v77, v92, v75 op_sel:[0,0] op_sel_hi:[1,0]
    v_pk_fma_f16 v94, v92, v75, v77 op_sel:[1,1,0] op_sel_hi:[0,1,1] neg_lo:[1,0,0]
    v_pk_mul_f16 v77, v92, v76 op_sel:[0,0] op_sel_hi:[1,0]
    v_pk_fma_f16 v95, v92, v76, v77 op_sel:[1,1,0] op_sel_hi:[0,1,1] neg_lo:[1,0,0]
    ds_write_addtid_b32 v92 offset:8704
    ds_write_addtid_b32 v93 offset:8976
    ds_write_addtid_b32 v94 offset:9248
    ds_write_addtid_b32 v95 offset:9520
    v_pk_mul_f32 v[62:63], v[60:61], v[66:67] op_sel:[0,0] op_sel_hi:[1,0]
    v_pk_fma_f32 v[60:61], v[60:61], v[66:67], v[62:63] op_sel:[1,1,0] op_sel_hi:[0,1,1] neg_lo:[1,0,0]
    v_cvt_pk_f16_f32 v96, v60, v61
    v_pk_mul_f16 v77, v96, v74 op_sel:[0,0] op_sel_hi:[1,0]
    v_pk_fma_f16 v97, v96, v74, v77 op_sel:[1,1,0] op_sel_hi:[0,1,1] neg_lo:[1,0,0]
    v_pk_mul_f16 v77, v96, v75 op_sel:[0,0] op_sel_hi:[1,0]
    v_pk_fma_f16 v98, v96, v75, v77 op_sel:[1,1,0] op_sel_hi:[0,1,1] neg_lo:[1,0,0]
    v_pk_mul_f16 v77, v96, v76 op_sel:[0,0] op_sel_hi:[1,0]
    v_pk_fma_f16 v99, v96, v76, v77 op_sel:[1,1,0] op_sel_hi:[0,1,1] neg_lo:[1,0,0]
    ds_write_addtid_b32 v96 offset:9792
    ds_write_addtid_b32 v97 offset:10064
    ds_write_addtid_b32 v98 offset:10336
    ds_write_addtid_b32 v99 offset:10608
    v_pk_mul_f32 v[62:63], v[60:61], v[66:67] op_sel:[0,0] op_sel_hi:[1,0]
    v_pk_fma_f32 v[60:61], v[60:61], v[66:67], v[62:63] op_sel:[1,1,0] op_sel_hi:[0,1,1] neg_lo:[1,0,0]
    v_cvt_pk_f16_f32 v88, v60, v61
    v_pk_mul_f16 v77, v88, v74 op_sel:[0,0] op_sel_hi:[1,0]
    v_pk_fma_f16 v89, v88, v74, v77 op_sel:[1,1,0] op_sel_hi:[0,1,1] neg_lo:[1,0,0]
    v_pk_mul_f16 v77, v88, v75 op_sel:[0,0] op_sel_hi:[1,0]
    v_pk_fma_f16 v90, v88, v75, v77 op_sel:[1,1,0] op_sel_hi:[0,1,1] neg_lo:[1,0,0]
    v_pk_mul_f16 v77, v88, v76 op_sel:[0,0] op_sel_hi:[1,0]
    v_pk_fma_f16 v91, v88, v76, v77 op_sel:[1,1,0] op_sel_hi:[0,1,1] neg_lo:[1,0,0]
    ds_write_addtid_b32 v88 offset:10880
    ds_write_addtid_b32 v89 offset:11152
    ds_write_addtid_b32 v90 offset:11424
    ds_write_addtid_b32 v91 offset:11696
    v_pk_mul_f32 v[62:63], v[60:61], v[66:67] op_sel:[0,0] op_sel_hi:[1,0]
    v_pk_fma_f32 v[60:61], v[60:61], v[66:67], v[62:63] op_sel:[1,1,0] op_sel_hi:[0,1,1] neg_lo:[1,0,0]
    v_cvt_pk_f16_f32 v92, v60, v61
    v_pk_mul_f16 v77, v92, v74 op_sel:[0,0] op_sel_hi:[1,0]
    v_pk_fma_f16 v93, v92, v74, v77 op_sel:[1,1,0] op_sel_hi:[0,1,1] neg_lo:[1,0,0]
    v_pk_mul_f16 v77, v92, v75 op_sel:[0,0] op_sel_hi:[1,0]
    v_pk_fma_f16 v94, v92, v75, v77 op_sel:[1,1,0] op_sel_hi:[0,1,1] neg_lo:[1,0,0]
    v_pk_mul_f16 v77, v92, v76 op_sel:[0,0] op_sel_hi:[1,0]
    v_pk_fma_f16 v95, v92, v76, v77 op_sel:[1,1,0] op_sel_hi:[0,1,1] neg_lo:[1,0,0]
    ds_write_addtid_b32 v92 offset:11968
    ds_write_addtid_b32 v93 offset:12240
    ds_write_addtid_b32 v94 offset:12512
    ds_write_addtid_b32 v95 offset:12784
    v_pk_mul_f32 v[62:63], v[60:61], v[66:67] op_sel:[0,0] op_sel_hi:[1,0]
    v_pk_fma_f32 v[60:61], v[60:61], v[66:67], v[62:63] op_sel:[1,1,0] op_sel_hi:[0,1,1] neg_lo:[1,0,0]
    v_cvt_pk_f16_f32 v96, v60, v61
    v_pk_mul_f16 v77, v96, v74 op_sel:[0,0] op_sel_hi:[1,0]
    v_pk_fma_f16 v97, v96, v74, v77 op_sel:[1,1,0] op_sel_hi:[0,1,1] neg_lo:[1,0,0]
    v_pk_mul_f16 v77, v96, v75 op_sel:[0,0] op_sel_hi:[1,0]
    v_pk_fma_f16 v98, v96, v75, v77 op_sel:[1,1,0] op_sel_hi:[0,1,1] neg_lo:[1,0,0]
    v_pk_mul_f16 v77, v96, v76 op_sel:[0,0] op_sel_hi:[1,0]
    v_pk_fma_f16 v99, v96, v76, v77 op_sel:[1,1,0] op_sel_hi:[0,1,1] neg_lo:[1,0,0]
    ds_write_addtid_b32 v96 offset:13056
    ds_write_addtid_b32 v97 offset:13328
    ds_write_addtid_b32 v98 offset:13600
    ds_write_addtid_b32 v99 offset:13872
    v_pk_mul_f32 v[62:63], v[60:61], v[66:67] op_sel:[0,0] op_sel_hi:[1,0]
    v_pk_fma_f32 v[60:61], v[60:61], v[66:67], v[62:63] op_sel:[1,1,0] op_sel_hi:[0,1,1] neg_lo:[1,0,0]
    v_cvt_pk_f16_f32 v88, v60, v61
    v_pk_mul_f16 v77, v88, v74 op_sel:[0,0] op_sel_hi:[1,0]
    v_pk_fma_f16 v89, v88, v74, v77 op_sel:[1,1,0] op_sel_hi:[0,1,1] neg_lo:[1,0,0]
    v_pk_mul_f16 v77, v88, v75 op_sel:[0,0] op_sel_hi:[1,0]
    v_pk_fma_f16 v90, v88, v75, v77 op_sel:[1,1,0] op_sel_hi:[0,1,1] neg_lo:[1,0,0]
    v_pk_mul_f16 v77, v88, v76 op_sel:[0,0] op_sel_hi:[1,0]
    v_pk_fma_f16 v91, v88, v76, v77 op_sel:[1,1,0] op_sel_hi:[0,1,1] neg_lo:[1,0,0]
    ds_write_addtid_b32 v88 offset:14144
    ds_write_addtid_b32 v89 offset:14416
    ds_write_addtid_b32 v90 offset:14688
    ds_write_addtid_b32 v91 offset:14960
    v_cvt_pk_f16_f32 v92, v40, -v41
    v_pk_mul_f32 v[62:63], v[40:41], v[52:53] op_sel:[0,0] op_sel_hi:[1,0]
    v_pk_fma_f32 v[60:61], v[40:41], v[52:53], v[62:63] op_sel:[1,1,0] op_sel_hi:[0,1,1] neg_lo:[1,0,0]
    v_cvt_pk_f16_f32 v93, v60, -v61
    v_pk_mul_f32 v[62:63], v[60:61], v[52:53] op_sel:[0,0] op_sel_hi:[1,0]
    v_pk_fma_f32 v[60:61], v[60:61], v[52:53], v[62:63] op_sel:[1,1,0] op_sel_hi:[0,1,1] neg_lo:[1,0,0]
    v_cvt_pk_f16_f32 v94, v60, -v61
    v_pk_mul_f32 v[62:63], v[60:61], v[52:53] op_sel:[0,0] op_sel_hi:[1,0]
    v_pk_fma_f32 v[60:61], v[60:61], v[52:53], v[62:63] op_sel:[1,1,0] op_sel_hi:[0,1,1] neg_lo:[1,0,0]
    v_cvt_pk_f16_f32 v95, v60, -v61
    ds_write_addtid_b32 v92 offset:0
    ds_write_addtid_b32 v93 offset:272
    ds_write_addtid_b32 v94 offset:544
    ds_write_addtid_b32 v95 offset:816
    v_pk_mul_f32 v[62:63], v[60:61], v[52:53] op_sel:[0,0] op_sel_hi:[1,0]
    v_pk_fma_f32 v[60:61], v[60:61], v[52:53], v[62:63] op_sel:[1,1,0] op_sel_hi:[0,1,1] neg_lo:[1,0,0]
    v_cvt_pk_f16_f32 v96, v60, -v61
    v_pk_mul_f32 v[62:63], v[60:61], v[52:53] op_sel:[0,0] op_sel_hi:[1,0]
    v_pk_fma_f32 v[60:61], v[60:61], v[52:53], v[62:63] op_sel:[1,1,0] op_sel_hi:[0,1,1] neg_lo:[1,0,0]
    v_cvt_pk_f16_f32 v97, v60, -v61
    v_pk_mul_f32 v[62:63], v[60:61], v[52:53] op_sel:[0,0] op_sel_hi:[1,0]
    v_pk_fma_f32 v[60:61], v[60:61], v[52:53], v[62:63] op_sel:[1,1,0] op_sel_hi:[0,1,1] neg_lo:[1,0,0]
    v_cvt_pk_f16_f32 v98, v60, -v61
    v_pk_mul_f32 v[62:63], v[60:61], v[52:53] op_sel:[0,0] op_sel_hi:[1,0]
    v_pk_fma_f32 v[60:61], v[60:61], v[52:53], v[62:63] op_sel:[1,1,0] op_sel_hi:[0,1,1] neg_lo:[1,0,0]
    v_cvt_pk_f16_f32 v99, v60, -v61
    ds_write_addtid_b32 v96 offset:2176
    ds_write_addtid_b32 v97 offset:2448
    ds_write_addtid_b32 v98 offset:2720
    ds_write_addtid_b32 v99 offset:2992
    v_pk_mul_f32 v[62:63], v[52:53], v[52:53] op_sel:[0,0] op_sel_hi:[1,0]
    v_pk_fma_f32 v[54:55], v[52:53], v[52:53], v[62:63] op_sel:[1,1,0] op_sel_hi:[0,1,1] neg_lo:[1,0,0]
    v_pk_mul_f32 v[62:63], v[40:41], v[58:59] op_sel:[0,0] op_sel_hi:[1,0]
    v_pk_fma_f32 v[60:61], v[40:41], v[58:59], v[62:63] op_sel:[1,1,0] op_sel_hi:[0,1,1] neg_lo:[1,0,0]
    v_cvt_pk_f16_f32 v88, v60, -v61
    v_pk_mul_f32 v[62:63], v[60:61], v[54:55] op_sel:[0,0] op_sel_hi:[1,0]
    v_pk_fma_f32 v[60:61], v[60:61], v[54:55], v[62:63] op_sel:[1,1,0] op_sel_hi:[0,1,1] neg_lo:[1,0,0]
    v_cvt_pk_f16_f32 v89, v60, -v61
    v_pk_mul_f32 v[62:63], v[60:61], v[54:55] op_sel:[0,0] op_sel_hi:[1,0]
    v_pk_fma_f32 v[64:65], v[60:61], v[54:55], v[62:63] op_sel:[1,1,0] op_sel_hi:[0,1,1] neg_lo:[1,0,0]
    v_cvt_pk_f16_f32 v90, v64, -v65
    ds_write_addtid_b32 v88 offset:1088
    ds_write_addtid_b32 v88 offset:1360
    ds_write_addtid_b32 v89 offset:1632
    ds_write_addtid_b32 v90 offset:1904
    ds_write_addtid_b32 v90 offset:3264
    ds_write_addtid_b32 v90 offset:3536
    v_pk_mul_f32 v[62:63], v[64:65], v[54:55] op_sel:[0,0] op_sel_hi:[1,0]
    v_pk_fma_f32 v[60:61], v[64:65], v[54:55], v[62:63] op_sel:[1,1,0] op_sel_hi:[0,1,1] neg_lo:[1,0,0]
    v_cvt_pk_f16_f32 v91, v60, -v61
    v_pk_mul_f32 v[62:63], v[60:61], v[54:55] op_sel:[0,0] op_sel_hi:[1,0]
    v_pk_fma_f32 v[60:61], v[60:61], v[54:55], v[62:63] op_sel:[1,1,0] op_sel_hi:[0,1,1] neg_lo:[1,0,0]
    v_cvt_pk_f16_f32 v92, v60, -v61
    v_pk_mul_f32 v[62:63], v[64:65], v[58:59] op_sel:[0,0] op_sel_hi:[1,0]
    v_pk_fma_f32 v[64:65], v[64:65], v[58:59], v[62:63] op_sel:[1,1,0] op_sel_hi:[0,1,1] neg_lo:[1,0,0]
    v_cvt_pk_f16_f32 v93, v64, -v65
    v_pk_mul_f32 v[62:63], v[60:61], v[58:59] op_sel:[0,0] op_sel_hi:[1,0]
    v_pk_fma_f32 v[60:61], v[60:61], v[58:59], v[62:63] op_sel:[1,1,0] op_sel_hi:[0,1,1] neg_lo:[1,0,0]
    v_cvt_pk_f16_f32 v94, v60, -v61
    ds_write_addtid_b32 v91 offset:3808
    ds_write_addtid_b32 v92 offset:4080
    ds_write_addtid_b32 v93 offset:4352
    ds_write_addtid_b32 v94 offset:4624
    v_pk_mul_f32 v[62:63], v[64:65], v[58:59] op_sel:[0,0] op_sel_hi:[1,0]
    v_pk_fma_f32 v[64:65], v[64:65], v[58:59], v[62:63] op_sel:[1,1,0] op_sel_hi:[0,1,1] neg_lo:[1,0,0]
    v_cvt_pk_f16_f32 v95, v64, -v65
    v_pk_mul_f32 v[62:63], v[60:61], v[58:59] op_sel:[0,0] op_sel_hi:[1,0]
    v_pk_fma_f32 v[60:61], v[60:61], v[58:59], v[62:63] op_sel:[1,1,0] op_sel_hi:[0,1,1] neg_lo:[1,0,0]
    v_cvt_pk_f16_f32 v96, v60, -v61
    v_pk_mul_f32 v[62:63], v[60:61], v[58:59] op_sel:[0,0] op_sel_hi:[1,0]
    v_pk_fma_f32 v[60:61], v[60:61], v[58:59], v[62:63] op_sel:[1,1,0] op_sel_hi:[0,1,1] neg_lo:[1,0,0]
    v_cvt_pk_f16_f32 v97, v60, -v61
    v_pk_mul_f32 v[62:63], v[60:61], v[58:59] op_sel:[0,0] op_sel_hi:[1,0]
    v_pk_fma_f32 v[60:61], v[60:61], v[58:59], v[62:63] op_sel:[1,1,0] op_sel_hi:[0,1,1] neg_lo:[1,0,0]
    v_cvt_pk_f16_f32 v98, v60, -v61
    ds_write_addtid_b32 v95 offset:5440
    ds_write_addtid_b32 v96 offset:5712
    ds_write_addtid_b32 v97 offset:4896
    ds_write_addtid_b32 v98 offset:5168
    v_pk_mul_f32 v[62:63], v[60:61], v[58:59] op_sel:[0,0] op_sel_hi:[1,0]
    v_pk_fma_f32 v[60:61], v[60:61], v[58:59], v[62:63] op_sel:[1,1,0] op_sel_hi:[0,1,1] neg_lo:[1,0,0]
    v_cvt_pk_f16_f32 v99, v60, -v61
    v_pk_mul_f32 v[62:63], v[60:61], v[58:59] op_sel:[0,0] op_sel_hi:[1,0]
    v_pk_fma_f32 v[60:61], v[60:61], v[58:59], v[62:63] op_sel:[1,1,0] op_sel_hi:[0,1,1] neg_lo:[1,0,0]
    v_cvt_pk_f16_f32 v88, v60, -v61
    ds_write_addtid_b32 v99 offset:5984
    ds_write_addtid_b32 v88 offset:6256
    ds_read_b128 v[160:163], v248 offset:0
    ds_read_b128 v[164:167], v248 offset:32
    ds_read_b128 v[168:171], v248 offset:64
    ds_read_b128 v[172:175], v248 offset:96
    ds_read_b128 v[176:179], v248 offset:128
    ds_read_b128 v[180:183], v248 offset:160
    ds_read_b128 v[184:187], v248 offset:192
    ds_read_b128 v[188:191], v248 offset:224
    ds_read_b128 v[192:195], v248 offset:6528
    ds_read_b128 v[196:199], v248 offset:6560
    ds_read_b128 v[200:203], v248 offset:6592
    ds_read_b128 v[204:207], v248 offset:6624
    ds_read_b128 v[208:211], v248 offset:6656
    ds_read_b128 v[212:215], v248 offset:6688
    ds_read_b128 v[216:219], v248 offset:6720
    ds_read_b128 v[220:223], v248 offset:6752
    v_mul_f32 v70, 0x41000000, v39
    v_mul_f32 v72, 0x41000000, v38
    v_fract_f32 v70, v70
    v_exp_f32 v72, v72
    v_cos_f32 v56, v70
    v_sin_f32 v57, v70
    s_nop 0
    v_pk_mul_f32 v[56:57], v[56:57], v[72:73] op_sel_hi:[1,0]
    v_fract_f32 v70, v39
    v_exp_f32 v72, v38
    v_cos_f32 v52, v70
    v_sin_f32 v53, v70
    s_nop 0
    v_pk_mul_f32 v[52:53], v[52:53], v[72:73] op_sel_hi:[1,0]
    v_mul_f32 v70, 0x43800000, v39
    v_mul_f32 v72, 0x43800000, v38
    v_fract_f32 v70, v70
    v_exp_f32 v72, v72
    v_cos_f32 v58, v70
    v_sin_f32 v59, v70
    s_nop 0
    v_pk_mul_f32 v[58:59], v[58:59], v[72:73] op_sel_hi:[1,0]
    v_pk_mul_f32 v[62:63], v[56:57], v[56:57] op_sel:[0,0] op_sel_hi:[1,0]
    v_pk_fma_f32 v[68:69], v[56:57], v[56:57], v[62:63] op_sel:[1,1,0] op_sel_hi:[0,1,1] neg_lo:[1,0,0]
    v_pk_mul_f32 v[62:63], v[68:69], v[56:57] op_sel:[0,0] op_sel_hi:[1,0]
    v_pk_fma_f32 v[60:61], v[68:69], v[56:57], v[62:63] op_sel:[1,1,0] op_sel_hi:[0,1,1] neg_lo:[1,0,0]
    v_pk_mul_f32 v[62:63], v[68:69], v[68:69] op_sel:[0,0] op_sel_hi:[1,0]
    v_pk_fma_f32 v[66:67], v[68:69], v[68:69], v[62:63] op_sel:[1,1,0] op_sel_hi:[0,1,1] neg_lo:[1,0,0]
    v_cvt_pk_f16_f32 v74, v56, v57
    v_cvt_pk_f16_f32 v75, v68, v69
    v_cvt_pk_f16_f32 v76, v60, v61
    ds_write_addtid_b32 v85 offset:6528
    ds_write_addtid_b32 v74 offset:6800
    ds_write_addtid_b32 v75 offset:7072
    ds_write_addtid_b32 v76 offset:7344
    s_waitcnt lgkmcnt(11)
    v_mfma_f32_32x32x16_f16 v[144:159], v[160:163], v[192:195], 0
    v_cvt_pk_f16_f32 v89, v66, v67
    v_pk_mul_f16 v77, v89, v74 op_sel:[0,0] op_sel_hi:[1,0]
    v_pk_fma_f16 v90, v89, v74, v77 op_sel:[1,1,0] op_sel_hi:[0,1,1] neg_lo:[1,0,0]
    v_pk_mul_f16 v77, v89, v75 op_sel:[0,0] op_sel_hi:[1,0]
    v_pk_fma_f16 v91, v89, v75, v77 op_sel:[1,1,0] op_sel_hi:[0,1,1] neg_lo:[1,0,0]
    v_pk_mul_f16 v77, v89, v76 op_sel:[0,0] op_sel_hi:[1,0]
    v_pk_fma_f16 v92, v89, v76, v77 op_sel:[1,1,0] op_sel_hi:[0,1,1] neg_lo:[1,0,0]
    ds_write_addtid_b32 v89 offset:7616
    ds_write_addtid_b32 v90 offset:7888
    ds_write_addtid_b32 v91 offset:8160
    ds_write_addtid_b32 v92 offset:8432
    s_waitcnt lgkmcnt(14)
    v_mfma_f32_32x32x16_f16 v[144:159], v[164:167], v[196:199], v[144:159]
    v_pk_mul_f32 v[62:63], v[66:67], v[66:67] op_sel:[0,0] op_sel_hi:[1,0]
    v_pk_fma_f32 v[60:61], v[66:67], v[66:67], v[62:63] op_sel:[1,1,0] op_sel_hi:[0,1,1] neg_lo:[1,0,0]
    v_cvt_pk_f16_f32 v93, v60, v61
    v_pk_mul_f16 v77, v93, v74 op_sel:[0,0] op_sel_hi:[1,0]
    v_pk_fma_f16 v94, v93, v74, v77 op_sel:[1,1,0] op_sel_hi:[0,1,1] neg_lo:[1,0,0]
    v_pk_mul_f16 v77, v93, v75 op_sel:[0,0] op_sel_hi:[1,0]
    v_pk_fma_f16 v95, v93, v75, v77 op_sel:[1,1,0] op_sel_hi:[0,1,1] neg_lo:[1,0,0]
    v_pk_mul_f16 v77, v93, v76 op_sel:[0,0] op_sel_hi:[1,0]
    v_pk_fma_f16 v96, v93, v76, v77 op_sel:[1,1,0] op_sel_hi:[0,1,1] neg_lo:[1,0,0]
    ds_write_addtid_b32 v93 offset:8704
    ds_write_addtid_b32 v94 offset:8976
    ds_write_addtid_b32 v95 offset:9248
    ds_write_addtid_b32 v96 offset:9520
    s_waitcnt lgkmcnt(15)
    v_mfma_f32_32x32x16_f16 v[144:159], v[168:171], v[200:203], v[144:159]
    v_pk_mul_f32 v[62:63], v[60:61], v[66:67] op_sel:[0,0] op_sel_hi:[1,0]
    v_pk_fma_f32 v[60:61], v[60:61], v[66:67], v[62:63] op_sel:[1,1,0] op_sel_hi:[0,1,1] neg_lo:[1,0,0]
    v_cvt_pk_f16_f32 v97, v60, v61
    v_pk_mul_f16 v77, v97, v74 op_sel:[0,0] op_sel_hi:[1,0]
    v_pk_fma_f16 v98, v97, v74, v77 op_sel:[1,1,0] op_sel_hi:[0,1,1] neg_lo:[1,0,0]
    v_pk_mul_f16 v77, v97, v75 op_sel:[0,0] op_sel_hi:[1,0]
    v_pk_fma_f16 v99, v97, v75, v77 op_sel:[1,1,0] op_sel_hi:[0,1,1] neg_lo:[1,0,0]
    v_pk_mul_f16 v77, v97, v76 op_sel:[0,0] op_sel_hi:[1,0]
    v_pk_fma_f16 v88, v97, v76, v77 op_sel:[1,1,0] op_sel_hi:[0,1,1] neg_lo:[1,0,0]
    ds_write_addtid_b32 v97 offset:9792
    ds_write_addtid_b32 v98 offset:10064
    ds_write_addtid_b32 v99 offset:10336
    ds_write_addtid_b32 v88 offset:10608
    v_mfma_f32_32x32x16_f16 v[144:159], v[172:175], v[204:207], v[144:159]
    v_pk_mul_f32 v[62:63], v[60:61], v[66:67] op_sel:[0,0] op_sel_hi:[1,0]
    v_pk_fma_f32 v[60:61], v[60:61], v[66:67], v[62:63] op_sel:[1,1,0] op_sel_hi:[0,1,1] neg_lo:[1,0,0]
    v_cvt_pk_f16_f32 v89, v60, v61
    v_pk_mul_f16 v77, v89, v74 op_sel:[0,0] op_sel_hi:[1,0]
    v_pk_fma_f16 v90, v89, v74, v77 op_sel:[1,1,0] op_sel_hi:[0,1,1] neg_lo:[1,0,0]
    v_pk_mul_f16 v77, v89, v75 op_sel:[0,0] op_sel_hi:[1,0]
    v_pk_fma_f16 v91, v89, v75, v77 op_sel:[1,1,0] op_sel_hi:[0,1,1] neg_lo:[1,0,0]
    v_pk_mul_f16 v77, v89, v76 op_sel:[0,0] op_sel_hi:[1,0]
    v_pk_fma_f16 v92, v89, v76, v77 op_sel:[1,1,0] op_sel_hi:[0,1,1] neg_lo:[1,0,0]
    ds_write_addtid_b32 v89 offset:10880
    ds_write_addtid_b32 v90 offset:11152
    ds_write_addtid_b32 v91 offset:11424
    ds_write_addtid_b32 v92 offset:11696
    v_mfma_f32_32x32x16_f16 v[144:159], v[176:179], v[208:211], v[144:159]
    v_pk_mul_f32 v[62:63], v[60:61], v[66:67] op_sel:[0,0] op_sel_hi:[1,0]
    v_pk_fma_f32 v[60:61], v[60:61], v[66:67], v[62:63] op_sel:[1,1,0] op_sel_hi:[0,1,1] neg_lo:[1,0,0]
    v_cvt_pk_f16_f32 v93, v60, v61
    v_pk_mul_f16 v77, v93, v74 op_sel:[0,0] op_sel_hi:[1,0]
    v_pk_fma_f16 v94, v93, v74, v77 op_sel:[1,1,0] op_sel_hi:[0,1,1] neg_lo:[1,0,0]
    v_pk_mul_f16 v77, v93, v75 op_sel:[0,0] op_sel_hi:[1,0]
    v_pk_fma_f16 v95, v93, v75, v77 op_sel:[1,1,0] op_sel_hi:[0,1,1] neg_lo:[1,0,0]
    v_pk_mul_f16 v77, v93, v76 op_sel:[0,0] op_sel_hi:[1,0]
    v_pk_fma_f16 v96, v93, v76, v77 op_sel:[1,1,0] op_sel_hi:[0,1,1] neg_lo:[1,0,0]
    ds_write_addtid_b32 v93 offset:11968
    ds_write_addtid_b32 v94 offset:12240
    ds_write_addtid_b32 v95 offset:12512
    ds_write_addtid_b32 v96 offset:12784
    s_waitcnt lgkmcnt(15)
    v_mfma_f32_32x32x16_f16 v[144:159], v[180:183], v[212:215], v[144:159]
    v_pk_mul_f32 v[62:63], v[60:61], v[66:67] op_sel:[0,0] op_sel_hi:[1,0]
    v_pk_fma_f32 v[60:61], v[60:61], v[66:67], v[62:63] op_sel:[1,1,0] op_sel_hi:[0,1,1] neg_lo:[1,0,0]
    v_cvt_pk_f16_f32 v97, v60, v61
    v_pk_mul_f16 v77, v97, v74 op_sel:[0,0] op_sel_hi:[1,0]
    v_pk_fma_f16 v98, v97, v74, v77 op_sel:[1,1,0] op_sel_hi:[0,1,1] neg_lo:[1,0,0]
    v_pk_mul_f16 v77, v97, v75 op_sel:[0,0] op_sel_hi:[1,0]
    v_pk_fma_f16 v99, v97, v75, v77 op_sel:[1,1,0] op_sel_hi:[0,1,1] neg_lo:[1,0,0]
    v_pk_mul_f16 v77, v97, v76 op_sel:[0,0] op_sel_hi:[1,0]
    v_pk_fma_f16 v88, v97, v76, v77 op_sel:[1,1,0] op_sel_hi:[0,1,1] neg_lo:[1,0,0]
    ds_write_addtid_b32 v97 offset:13056
    ds_write_addtid_b32 v98 offset:13328
    ds_write_addtid_b32 v99 offset:13600
    ds_write_addtid_b32 v88 offset:13872
    v_mfma_f32_32x32x16_f16 v[144:159], v[184:187], v[216:219], v[144:159]
    v_pk_mul_f32 v[62:63], v[60:61], v[66:67] op_sel:[0,0] op_sel_hi:[1,0]
    v_pk_fma_f32 v[60:61], v[60:61], v[66:67], v[62:63] op_sel:[1,1,0] op_sel_hi:[0,1,1] neg_lo:[1,0,0]
    v_cvt_pk_f16_f32 v89, v60, v61
    v_pk_mul_f16 v77, v89, v74 op_sel:[0,0] op_sel_hi:[1,0]
    v_pk_fma_f16 v90, v89, v74, v77 op_sel:[1,1,0] op_sel_hi:[0,1,1] neg_lo:[1,0,0]
    v_pk_mul_f16 v77, v89, v75 op_sel:[0,0] op_sel_hi:[1,0]
    v_pk_fma_f16 v91, v89, v75, v77 op_sel:[1,1,0] op_sel_hi:[0,1,1] neg_lo:[1,0,0]
    v_pk_mul_f16 v77, v89, v76 op_sel:[0,0] op_sel_hi:[1,0]
    v_pk_fma_f16 v92, v89, v76, v77 op_sel:[1,1,0] op_sel_hi:[0,1,1] neg_lo:[1,0,0]
    ds_write_addtid_b32 v89 offset:14144
    ds_write_addtid_b32 v90 offset:14416
    ds_write_addtid_b32 v91 offset:14688
    ds_write_addtid_b32 v92 offset:14960
    v_mfma_f32_32x32x16_f16 v[144:159], v[188:191], v[220:223], v[144:159]
    ds_read_b128 v[192:195], v248 offset:6528
    ds_read_b128 v[196:199], v248 offset:6560
    ds_read_b128 v[200:203], v248 offset:6592
    ds_read_b128 v[204:207], v248 offset:6624
    ds_read_b128 v[208:211], v248 offset:6656
    ds_read_b128 v[212:215], v248 offset:6688
    ds_read_b128 v[216:219], v248 offset:6720
    ds_read_b128 v[220:223], v248 offset:6752
    v_cvt_pk_f16_f32 v93, v42, -v43
    v_pk_mul_f32 v[62:63], v[42:43], v[52:53] op_sel:[0,0] op_sel_hi:[1,0]
    v_pk_fma_f32 v[60:61], v[42:43], v[52:53], v[62:63] op_sel:[1,1,0] op_sel_hi:[0,1,1] neg_lo:[1,0,0]
    v_cvt_pk_f16_f32 v94, v60, -v61
    v_pk_mul_f32 v[62:63], v[60:61], v[52:53] op_sel:[0,0] op_sel_hi:[1,0]
    v_pk_fma_f32 v[60:61], v[60:61], v[52:53], v[62:63] op_sel:[1,1,0] op_sel_hi:[0,1,1] neg_lo:[1,0,0]
    v_cvt_pk_f16_f32 v95, v60, -v61
    v_pk_mul_f32 v[62:63], v[60:61], v[52:53] op_sel:[0,0] op_sel_hi:[1,0]
    v_pk_fma_f32 v[60:61], v[60:61], v[52:53], v[62:63] op_sel:[1,1,0] op_sel_hi:[0,1,1] neg_lo:[1,0,0]
    v_cvt_pk_f16_f32 v96, v60, -v61
    ds_write_addtid_b32 v93 offset:0
    ds_write_addtid_b32 v94 offset:272
    ds_write_addtid_b32 v95 offset:544
    ds_write_addtid_b32 v96 offset:816
    v_pk_mul_f32 v[62:63], v[60:61], v[52:53] op_sel:[0,0] op_sel_hi:[1,0]
    v_pk_fma_f32 v[60:61], v[60:61], v[52:53], v[62:63] op_sel:[1,1,0] op_sel_hi:[0,1,1] neg_lo:[1,0,0]
    v_cvt_pk_f16_f32 v97, v60, -v61
    v_pk_mul_f32 v[62:63], v[60:61], v[52:53] op_sel:[0,0] op_sel_hi:[1,0]
    v_pk_fma_f32 v[60:61], v[60:61], v[52:53], v[62:63] op_sel:[1,1,0] op_sel_hi:[0,1,1] neg_lo:[1,0,0]
    v_cvt_pk_f16_f32 v98, v60, -v61
    v_pk_mul_f32 v[62:63], v[60:61], v[52:53] op_sel:[0,0] op_sel_hi:[1,0]
    v_pk_fma_f32 v[60:61], v[60:61], v[52:53], v[62:63] op_sel:[1,1,0] op_sel_hi:[0,1,1] neg_lo:[1,0,0]
    v_cvt_pk_f16_f32 v99, v60, -v61
    v_pk_mul_f32 v[62:63], v[60:61], v[52:53] op_sel:[0,0] op_sel_hi:[1,0]
    v_pk_fma_f32 v[60:61], v[60:61], v[52:53], v[62:63] op_sel:[1,1,0] op_sel_hi:[0,1,1] neg_lo:[1,0,0]
    v_cvt_pk_f16_f32 v88, v60, -v61
    ds_write_addtid_b32 v97 offset:2176
    ds_write_addtid_b32 v98 offset:2448
    ds_write_addtid_b32 v99 offset:2720
    ds_write_addtid_b32 v88 offset:2992
    v_pk_mul_f32 v[62:63], v[52:53], v[52:53] op_sel:[0,0] op_sel_hi:[1,0]
    v_pk_fma_f32 v[54:55], v[52:53], v[52:53], v[62:63] op_sel:[1,1,0] op_sel_hi:[0,1,1] neg_lo:[1,0,0]
    v_pk_mul_f32 v[62:63], v[42:43], v[58:59] op_sel:[0,0] op_sel_hi:[1,0]
    v_pk_fma_f32 v[60:61], v[42:43], v[58:59], v[62:63] op_sel:[1,1,0] op_sel_hi:[0,1,1] neg_lo:[1,0,0]
    v_cvt_pk_f16_f32 v89, v60, -v61
    v_pk_mul_f32 v[62:63], v[60:61], v[54:55] op_sel:[0,0] op_sel_hi:[1,0]
    v_pk_fma_f32 v[60:61], v[60:61], v[54:55], v[62:63] op_sel:[1,1,0] op_sel_hi:[0,1,1] neg_lo:[1,0,0]
    v_cvt_pk_f16_f32 v90, v60, -v61
    v_pk_mul_f32 v[62:63], v[60:61], v[54:55] op_sel:[0,0] op_sel_hi:[1,0]
    v_pk_fma_f32 v[64:65], v[60:61], v[54:55], v[62:63] op_sel:[1,1,0] op_sel_hi:[0,1,1] neg_lo:[1,0,0]
    v_cvt_pk_f16_f32 v91, v64, -v65
    ds_write_addtid_b32 v89 offset:1088
    ds_write_addtid_b32 v89 offset:1360
    ds_write_addtid_b32 v90 offset:1632
    ds_write_addtid_b32 v91 offset:1904
    ds_write_addtid_b32 v91 offset:3264
    ds_write_addtid_b32 v91 offset:3536
    v_pk_mul_f32 v[62:63], v[64:65], v[54:55] op_sel:[0,0] op_sel_hi:[1,0]
    v_pk_fma_f32 v[60:61], v[64:65], v[54:55], v[62:63] op_sel:[1,1,0] op_sel_hi:[0,1,1] neg_lo:[1,0,0]
    v_cvt_pk_f16_f32 v92, v60, -v61
    v_pk_mul_f32 v[62:63], v[60:61], v[54:55] op_sel:[0,0] op_sel_hi:[1,0]
    v_pk_fma_f32 v[60:61], v[60:61], v[54:55], v[62:63] op_sel:[1,1,0] op_sel_hi:[0,1,1] neg_lo:[1,0,0]
    v_cvt_pk_f16_f32 v93, v60, -v61
    v_pk_mul_f32 v[62:63], v[64:65], v[58:59] op_sel:[0,0] op_sel_hi:[1,0]
    v_pk_fma_f32 v[64:65], v[64:65], v[58:59], v[62:63] op_sel:[1,1,0] op_sel_hi:[0,1,1] neg_lo:[1,0,0]
    v_cvt_pk_f16_f32 v94, v64, -v65
    v_pk_mul_f32 v[62:63], v[60:61], v[58:59] op_sel:[0,0] op_sel_hi:[1,0]
    v_pk_fma_f32 v[60:61], v[60:61], v[58:59], v[62:63] op_sel:[1,1,0] op_sel_hi:[0,1,1] neg_lo:[1,0,0]
    v_cvt_pk_f16_f32 v95, v60, -v61
    ds_write_addtid_b32 v92 offset:3808
    ds_write_addtid_b32 v93 offset:4080
    ds_write_addtid_b32 v94 offset:4352
    ds_write_addtid_b32 v95 offset:4624
    v_pk_mul_f32 v[62:63], v[64:65], v[58:59] op_sel:[0,0] op_sel_hi:[1,0]
    v_pk_fma_f32 v[64:65], v[64:65], v[58:59], v[62:63] op_sel:[1,1,0] op_sel_hi:[0,1,1] neg_lo:[1,0,0]
    v_cvt_pk_f16_f32 v96, v64, -v65
    v_pk_mul_f32 v[62:63], v[60:61], v[58:59] op_sel:[0,0] op_sel_hi:[1,0]
    v_pk_fma_f32 v[60:61], v[60:61], v[58:59], v[62:63] op_sel:[1,1,0] op_sel_hi:[0,1,1] neg_lo:[1,0,0]
    v_cvt_pk_f16_f32 v97, v60, -v61
    v_pk_mul_f32 v[62:63], v[60:61], v[58:59] op_sel:[0,0] op_sel_hi:[1,0]
    v_pk_fma_f32 v[60:61], v[60:61], v[58:59], v[62:63] op_sel:[1,1,0] op_sel_hi:[0,1,1] neg_lo:[1,0,0]
    v_cvt_pk_f16_f32 v98, v60, -v61
    v_pk_mul_f32 v[62:63], v[60:61], v[58:59] op_sel:[0,0] op_sel_hi:[1,0]
    v_pk_fma_f32 v[60:61], v[60:61], v[58:59], v[62:63] op_sel:[1,1,0] op_sel_hi:[0,1,1] neg_lo:[1,0,0]
    v_cvt_pk_f16_f32 v99, v60, -v61
    ds_write_addtid_b32 v96 offset:5440
    ds_write_addtid_b32 v97 offset:5712
    ds_write_addtid_b32 v98 offset:4896
    ds_write_addtid_b32 v99 offset:5168
    v_pk_mul_f32 v[62:63], v[60:61], v[58:59] op_sel:[0,0] op_sel_hi:[1,0]
    v_pk_fma_f32 v[60:61], v[60:61], v[58:59], v[62:63] op_sel:[1,1,0] op_sel_hi:[0,1,1] neg_lo:[1,0,0]
    v_cvt_pk_f16_f32 v88, v60, -v61
    v_pk_mul_f32 v[62:63], v[60:61], v[58:59] op_sel:[0,0] op_sel_hi:[1,0]
    v_pk_fma_f32 v[60:61], v[60:61], v[58:59], v[62:63] op_sel:[1,1,0] op_sel_hi:[0,1,1] neg_lo:[1,0,0]
    v_cvt_pk_f16_f32 v89, v60, -v61
    ds_write_addtid_b32 v88 offset:5984
    ds_write_addtid_b32 v89 offset:6256
    ds_read_b128 v[160:163], v248 offset:0
    ds_read_b128 v[164:167], v248 offset:32
    ds_read_b128 v[168:171], v248 offset:64
    ds_read_b128 v[172:175], v248 offset:96
    ds_read_b128 v[176:179], v248 offset:128
    ds_read_b128 v[180:183], v248 offset:160
    ds_read_b128 v[184:187], v248 offset:192
    ds_read_b128 v[188:191], v248 offset:224
    global_load_dwordx4 v[12:15], v247, s[44:45] offset:0
    global_load_dwordx4 v[16:19], v247, s[44:45] offset:1024
    global_load_dwordx4 v[20:23], v247, s[44:45] offset:2048
    global_load_dwordx4 v[24:27], v247, s[44:45] offset:3072
    global_load_dwordx4 v[28:31], v224, s[44:45] offset:0
    global_load_dwordx4 v[32:35], v224, s[44:45] offset:1024
    v_and_b32 v40, 15, v1
    v_lshrrev_b32 v41, 4, v1
    v_and_b32 v42, 31, v1
    v_lshrrev_b32 v43, 5, v1
    v_and_b32 v44, 1, v1
    v_mov_b32 v252, s57
    s_add_u32 s59, s57, 2880
    v_sub_u32 v249, s59, v2
    v_lshlrev_b32 v45, 8, v44
    v_lshrrev_b32 v46, 1, v1
    v_lshlrev_b32 v46, 2, v46
    v_sub_u32 v45, v45, v46
    s_add_u32 s59, s57, 188
    v_add_u32 v250, s59, v45
    v_lshrrev_b32 v45, 1, v42
    v_lshl_add_u32 v45, v43, 5, v45
    s_waitcnt lgkmcnt(7)
    v_mfma_f32_32x32x16_f16 v[144:159], v[160:163], v[192:195], v[144:159]
    v_lshlrev_b32 v45, 2, v45
    v_lshlrev_b32 v46, 1, v44
    v_sub_u32 v45, v46, v45
    s_add_u32 s59, s57, 700
    s_waitcnt lgkmcnt(6)
    v_mfma_f32_32x32x16_f16 v[144:159], v[164:167], v[196:199], v[144:159]
    v_add_u32 v251, s59, v45
    v_lshlrev_b32 v45, 2, v41
    v_sub_u32 v46, v45, v40
    v_lshlrev_b32 v46, 2, v46
    s_waitcnt lgkmcnt(5)
    v_mfma_f32_32x32x16_f16 v[144:159], v[168:171], v[200:203], v[144:159]
    v_mul_u32_u24 v45, 900, v44
    v_sub_u32 v46, v46, v45
    s_add_u32 s59, s57, 960
    v_add_u32 v253, s59, v46
    s_waitcnt lgkmcnt(4)
    v_mfma_f32_32x32x16_f16 v[144:159], v[172:175], v[204:207], v[144:159]
    v_and_b32 v45, 3, v1
    v_mul_u32_u24 v45, 1216, v45
    v_lshl_add_u32 v45, v41, 4, v45
    v_and_b32 v46, 12, v1
    s_waitcnt lgkmcnt(3)
    v_mfma_f32_32x32x16_f16 v[144:159], v[176:179], v[208:211], v[144:159]
    v_lshlrev_b32 v46, 1, v46
    v_sub_u32 v45, v45, v46
    s_add_u32 s59, s57, 1832
    v_add_u32 v254, s59, v45
    s_waitcnt lgkmcnt(2)
    v_mfma_f32_32x32x16_f16 v[144:159], v[180:183], v[212:215], v[144:159]
    v_lshlrev_b32 v2, 5, v40
    v_lshl_add_u32 v2, v41, 4, v2
    v_add_u32 v2, s61, v2
    v_lshlrev_b32 v45, 2, v1
    s_waitcnt lgkmcnt(1)
    v_mfma_f32_32x32x16_f16 v[144:159], v[184:187], v[216:219], v[144:159]
    v_add_u32 v45, 141184, v45
    s_add_u32 s59, s39, 141056
    v_mov_b32 v46, s59
    v_cndmask_b32 v3, v45, v46, vcc
    s_waitcnt lgkmcnt(0)
    v_mfma_f32_32x32x16_f16 v[144:159], v[188:191], v[220:223], v[144:159]
    s_nop 11
    v_add_f32 v144, v144, v10
    v_mov_b32_dpp v36, v151 wave_shr:1 row_mask:0xf bank_mask:0xf bound_ctrl:0
    v_cvt_pk_f16_f32 v40, v151, v150
    v_cvt_pk_f16_f32 v44, v150, v149
    v_cvt_pk_f16_f32 v41, v149, v148
    v_cvt_pk_f16_f32 v42, v147, v146
    v_cvt_pk_f16_f32 v43, v145, v144
    v_cvt_pk_f16_f32 v45, v148, v147
    v_cvt_pk_f16_f32 v46, v146, v145
    v_cvt_pk_f16_f32 v47, v144, v36
    v_mov_b32_dpp v51, v40 wave_shr:1 row_mask:0xf bank_mask:0xf bound_ctrl:0
    v_mov_b32_dpp v55, v44 wave_shr:1 row_mask:0xf bank_mask:0xf bound_ctrl:0
    v_mov_b32 v48, v41
    v_mov_b32 v49, v42
    v_mov_b32 v50, v43
    v_mov_b32 v52, v45
    v_mov_b32 v53, v46
    v_mov_b32 v54, v47
    v_cvt_pk_f16_f32 v57, v151, v151
    v_cvt_pk_f16_f32 v56, 0, v151
    v_cvt_pk_f16_f32 v58, v152, v153
    v_cvt_pk_f16_f32 v59, v154, v155
    v_cvt_pk_f16_f32 v60, v153, v153
    ds_write_b128 v249, v[40:43] offset:3648
    ds_write_b128 v249, v[44:47] offset:2432
    ds_write_b128 v249, v[48:51] offset:1216
    ds_write_b128 v249, v[52:55]
    s_mov_b32 exec_lo, 0
    s_mov_b32 exec_hi, 0x80000000
    ds_write_b64 v252, v[56:57] offset:5512
    ds_write_b32 v252, v57 offset:4296
    ds_write_b32 v252, v57 offset:4300
    ds_write_b32 v252, v56 offset:3076
    ds_write_b32 v252, v57 offset:3080
    ds_write_b32 v252, v40 offset:3084
    ds_write_b32 v252, v57 offset:1860
    ds_write_b32 v252, v57 offset:1864
    ds_write_b32 v252, v44 offset:1868
    s_mov_b64 exec, -1
    ds_write_b32 v250, v58
    ds_write_b32 v250, v58 offset:900
    ds_write_b16 v251, v59 offset:64
    ds_write_b16_d16_hi v251, v59
    ds_write_b16 v251, v59 offset:964
    ds_write_b16_d16_hi v251, v59 offset:900
    v_readlane_b32 s60, v60, 63
    ds_read_b64 v[100:101], v254 offset:0
    ds_read_b64 v[102:103], v254 offset:8
    ds_read_b64 v[96:97], v254 offset:64
    ds_read_b64 v[98:99], v254 offset:72
    ds_read_b64 v[92:93], v254 offset:128
    ds_read_b64 v[94:95], v254 offset:136
    ds_read_b64 v[88:89], v254 offset:192
    ds_read_b64 v[90:91], v254 offset:200
    ds_read_b64 v[84:85], v254 offset:256
    ds_read_b64 v[86:87], v254 offset:264
    ds_read_b64 v[80:81], v254 offset:320
    ds_read_b64 v[82:83], v254 offset:328
    ds_read_b64 v[76:77], v254 offset:384
    ds_read_b64 v[78:79], v254 offset:392
    ds_read_b64 v[72:73], v254 offset:448
    ds_read_b64 v[74:75], v254 offset:456
    ds_read_b64 v[68:69], v254 offset:512
    ds_read_b64 v[70:71], v254 offset:520
    ds_read_b64 v[64:65], v254 offset:576
    ds_read_b64 v[66:67], v254 offset:584
    ds_read_b64 v[60:61], v254 offset:640
    ds_read_b64 v[62:63], v254 offset:648
    ds_read_b64 v[56:57], v254 offset:704
    ds_read_b64 v[58:59], v254 offset:712
    ds_read_b64 v[52:53], v254 offset:768
    ds_read_b64 v[54:55], v254 offset:776
    ds_read_b64 v[48:49], v254 offset:832
    ds_read_b64 v[50:51], v254 offset:840
    ds_read_b64 v[44:45], v254 offset:896
    ds_read_b64 v[46:47], v254 offset:904
    ds_read_b64 v[40:41], v254 offset:960
    ds_read_b64 v[42:43], v254 offset:968
    ds_read_b64 v[36:37], v254 offset:1024
    ds_read_b64 v[38:39], v254 offset:1032
    v_mov_b32 v10, 141056
    v_mov_b32 v252, 1
    s_waitcnt vmcnt(0)
    v_and_b32 v32, s60, v32
    v_and_b32 v33, s60, v33
    v_and_b32 v34, s60, v34
    v_and_b32 v35, s60, v35
    s_cmp_eq_u32 s41, 0
    s_cbranch_scc0 L_convY
    ds_read_b64 v[104:105], v253 offset:0
    ds_read_b64 v[106:107], v253 offset:8
    ds_read_b64 v[108:109], v253 offset:64
    ds_read_b64 v[110:111], v253 offset:72
    ds_read_b64 v[112:113], v253 offset:128
    ds_read_b64 v[114:115], v253 offset:136
    ds_read_b64 v[116:117], v253 offset:256
    ds_read_b64 v[118:119], v253 offset:264
    ds_read_b64 v[120:121], v253 offset:320
    ds_read_b64 v[122:123], v253 offset:328
    ds_read_b64 v[124:125], v253 offset:384
    ds_read_b64 v[126:127], v253 offset:392
    ds_read_b64 v[128:129], v253 offset:704
    ds_read_b64 v[130:131], v253 offset:712
    ds_read_b64 v[132:133], v253 offset:640
    ds_read_b64 v[134:135], v253 offset:648
    ds_read_b64 v[136:137], v253 offset:576
    ds_read_b64 v[138:139], v253 offset:584
    ds_read_b64 v[140:141], v253 offset:512
    ds_read_b64 v[142:143], v253 offset:520
    s_waitcnt lgkmcnt(0)
    s_mov_b32 s53, 0
spin_31:
    ds_read_b32 v144, v10 offset:20
    s_waitcnt lgkmcnt(0)
    v_readfirstlane_b32 s52, v144
    s_add_u32 s53, s53, 1
    s_cmp_eq_u32 s52, 257
    s_cbranch_scc1 spun_32
    s_cmp_lt_u32 s53, 3200000
    s_sleep 1
    s_cbranch_scc1 spin_31
spun_32:
    ds_read_b128 v[224:227], v2 offset:32
    ds_read_b128 v[228:231], v2 offset:96
    ds_read_b128 v[232:235], v2 offset:160
    s_waitcnt lgkmcnt(2)
    ds_read_b128 v[236:239], v2 offset:224
    ds_read_b128 v[240:243], v2 offset:288
    v_mfma_f32_16x16x32_f16 v[144:147], v[64:67], v[224:227], 0
    s_waitcnt lgkmcnt(3)
    ds_read_b128 v[244:247], v2 offset:352
    ds_read_b128 v[248:251], v2 offset:416
    v_mfma_f32_16x16x32_f16 v[144:147], v[60:63], v[228:231], v[144:147]
    s_waitcnt lgkmcnt(4)
    ds_read_b128 v[4:7], v2 offset:480
    ds_read_b128 v[224:227], v2 offset:464
    v_mfma_f32_16x16x32_f16 v[144:147], v[56:59], v[232:235], v[144:147]
    s_waitcnt lgkmcnt(5)
    ds_read_b128 v[228:231], v2 offset:32
    ds_read_b128 v[232:235], v2 offset:96
    v_mfma_f32_16x16x32_f16 v[144:147], v[52:55], v[236:239], v[144:147]
    s_waitcnt lgkmcnt(6)
    ds_read_b128 v[236:239], v2 offset:160
    v_mfma_f32_16x16x32_f16 v[144:147], v[48:51], v[240:243], v[144:147]
    s_waitcnt lgkmcnt(6)
    ds_read_b128 v[240:243], v2 offset:224
    v_mfma_f32_16x16x32_f16 v[144:147], v[44:47], v[244:247], v[144:147]
    s_waitcnt lgkmcnt(6)
    ds_read_b128 v[244:247], v2 offset:288
    v_mfma_f32_16x16x32_f16 v[144:147], v[40:43], v[248:251], v[144:147]
    s_waitcnt lgkmcnt(6)
    ds_read_b128 v[248:251], v2 offset:352
    v_mfma_f32_16x16x32_f16 v[144:147], v[36:39], v[4:7], v[144:147]
    v_mfma_f32_16x16x32_f16 v[160:163], v[4:7], v[24:27], 0
    s_waitcnt lgkmcnt(6)
    ds_read_b128 v[4:7], v2 offset:416
    v_mfma_f32_16x16x32_f16 v[164:167], v[224:227], v[28:31], 0
    s_waitcnt lgkmcnt(6)
    ds_read_b128 v[224:227], v2 offset:480
    v_mfma_f32_16x16x32_f16 v[148:151], v[96:99], v[228:231], 0
    s_waitcnt lgkmcnt(6)
    ds_read_b128 v[228:231], v2 offset:544
    ds_write_addtid_b32 v144 offset:0
    v_mfma_f32_16x16x32_f16 v[148:151], v[92:95], v[232:235], v[148:151]
    s_waitcnt lgkmcnt(7)
    ds_read_b128 v[232:235], v2 offset:608
    ds_write_addtid_b32 v145 offset:264
    v_mfma_f32_16x16x32_f16 v[148:151], v[88:91], v[236:239], v[148:151]
    s_waitcnt lgkmcnt(8)
    ds_read_b128 v[236:239], v2 offset:672
    ds_write_addtid_b32 v146 offset:528
    v_mfma_f32_16x16x32_f16 v[148:151], v[84:87], v[240:243], v[148:151]
    s_waitcnt lgkmcnt(9)
    ds_read_b128 v[240:243], v2 offset:736
    ds_write_addtid_b32 v147 offset:792
    v_mfma_f32_16x16x32_f16 v[148:151], v[80:83], v[244:247], v[148:151]
    s_waitcnt lgkmcnt(10)
    ds_read_b128 v[244:247], v2 offset:800
    ds_write_b8 v3, v252 offset:32
    v_mfma_f32_16x16x32_f16 v[148:151], v[76:79], v[248:251], v[148:151]
    s_waitcnt lgkmcnt(11)
    ds_read_b128 v[248:251], v2 offset:864
    v_cvt_pk_f16_f32 v208, v160, v164
    v_mfma_f32_16x16x32_f16 v[148:151], v[72:75], v[4:7], v[148:151]
    s_waitcnt lgkmcnt(11)
    ds_read_b128 v[4:7], v2 offset:928
    v_cvt_pk_f16_f32 v209, v161, v165
    v_mfma_f32_16x16x32_f16 v[148:151], v[68:71], v[224:227], v[148:151]
    s_waitcnt lgkmcnt(11)
    ds_read_b128 v[224:227], v2 offset:992
    v_cvt_pk_f16_f32 v210, v162, v166
    v_mfma_f32_16x16x32_f16 v[148:151], v[64:67], v[228:231], v[148:151]
    s_waitcnt lgkmcnt(10)
    ds_read_b128 v[228:231], v2 offset:976
    v_cvt_pk_f16_f32 v211, v163, v167
    v_mfma_f32_16x16x32_f16 v[148:151], v[60:63], v[232:235], v[148:151]
    s_waitcnt lgkmcnt(9)
    ds_read_b128 v[232:235], v2 offset:1504
    v_mfma_f32_16x16x32_f16 v[148:151], v[56:59], v[236:239], v[148:151]
    s_waitcnt lgkmcnt(8)
    ds_read_b128 v[236:239], v2 offset:1488
    v_mfma_f32_16x16x32_f16 v[148:151], v[52:55], v[240:243], v[148:151]
    s_waitcnt lgkmcnt(7)
    ds_read_b128 v[240:243], v2 offset:2016
    v_mfma_f32_16x16x32_f16 v[148:151], v[48:51], v[244:247], v[148:151]
    s_waitcnt lgkmcnt(6)
    ds_read_b128 v[244:247], v2 offset:2000
    v_mfma_f32_16x16x32_f16 v[148:151], v[44:47], v[248:251], v[148:151]
    s_waitcnt lgkmcnt(6)
    ds_read_b128 v[248:251], v2 offset:2528
    v_mfma_f32_16x16x32_f16 v[148:151], v[40:43], v[4:7], v[148:151]
    s_waitcnt lgkmcnt(6)
    ds_read_b128 v[4:7], v2 offset:2512
    v_mfma_f32_16x16x32_f16 v[148:151], v[36:39], v[224:227], v[148:151]
    v_mfma_f32_16x16x32_f16 v[168:171], v[224:227], v[24:27], 0
    s_waitcnt lgkmcnt(6)
    ds_read_b128 v[224:227], v2 offset:2592
    v_mfma_f32_16x16x32_f16 v[172:175], v[228:231], v[28:31], 0
    s_waitcnt lgkmcnt(6)
    ds_read_b128 v[228:231], v2 offset:2656
    v_mfma_f32_16x16x32_f16 v[160:163], v[232:235], v[12:15], 0
    v_mfma_f32_16x16x32_f16 v[164:167], v[232:235], v[16:19], 0
    ds_write_addtid_b32 v148 offset:1056
    ds_write_addtid_b32 v149 offset:1320
    v_mfma_f32_16x16x32_f16 v[152:155], v[32:35], v[232:235], 0
    ds_write_addtid_b32 v150 offset:1584
    ds_write_addtid_b32 v151 offset:1848
    v_cvt_pk_f16_f32 v212, v168, v172
    v_cvt_pk_f16_f32 v213, v169, v173
    v_cvt_pk_f16_f32 v214, v170, v174
    v_cvt_pk_f16_f32 v215, v171, v175
    v_mfma_f32_16x16x32_f16 v[168:171], v[232:235], v[20:23], 0
    s_waitcnt lgkmcnt(10)
    v_cvt_pk_f16_f32 v176, v160, v164
    v_cvt_pk_f16_f32 v177, v161, v165
    v_mfma_f32_16x16x32_f16 v[172:175], v[236:239], v[16:19], 0
    v_cvt_pk_f16_f32 v178, v162, v166
    v_cvt_pk_f16_f32 v179, v163, v167
    v_mfma_f32_16x16x32_f16 v[152:155], v[208:211], v[136:139], v[152:155]
    ds_write_b8 v3, v252 offset:36
    v_mfma_f32_16x16x32_f16 v[160:163], v[232:235], v[24:27], 0
    ds_read_b128 v[232:235], v2 offset:2720
    v_mfma_f32_16x16x32_f16 v[164:167], v[236:239], v[28:31], 0
    ds_read_b128 v[236:239], v2 offset:2784
    v_mfma_f32_16x16x32_f16 v[152:155], v[212:215], v[132:135], v[152:155]
    s_waitcnt lgkmcnt(12)
    v_cvt_pk_f16_f32 v180, v168, v172
    v_cvt_pk_f16_f32 v181, v169, v173
    v_cvt_pk_f16_f32 v182, v170, v174
    v_cvt_pk_f16_f32 v183, v171, v175
    v_mfma_f32_16x16x32_f16 v[168:171], v[240:243], v[12:15], 0
    v_cvt_pk_f16_f32 v216, v160, v164
    v_cvt_pk_f16_f32 v217, v161, v165
    v_mfma_f32_16x16x32_f16 v[172:175], v[240:243], v[16:19], 0
    v_cvt_pk_f16_f32 v218, v162, v166
    v_cvt_pk_f16_f32 v219, v163, v167
    v_mfma_f32_16x16x32_f16 v[156:159], v[32:35], v[240:243], 0
    v_mfma_f32_16x16x32_f16 v[160:163], v[240:243], v[20:23], 0
    s_waitcnt lgkmcnt(11)
    ds_read_b128 v[240:243], v2 offset:2848
    v_mfma_f32_16x16x32_f16 v[164:167], v[244:247], v[16:19], 0
    s_waitcnt lgkmcnt(11)
    v_cvt_pk_f16_f32 v184, v168, v172
    v_cvt_pk_f16_f32 v185, v169, v173
    v_mfma_f32_16x16x32_f16 v[152:155], v[100:103], v[248:251], v[152:155]
    v_cvt_pk_f16_f32 v186, v170, v174
    v_cvt_pk_f16_f32 v187, v171, v175
    v_mfma_f32_16x16x32_f16 v[168:171], v[248:251], v[12:15], 0
    ds_read_b128 v[244:247], v2 offset:2912
    v_mfma_f32_16x16x32_f16 v[172:175], v[248:251], v[16:19], 0
    v_cvt_pk_f16_f32 v188, v160, v164
    v_cvt_pk_f16_f32 v189, v161, v165
    v_cvt_pk_f16_f32 v190, v162, v166
    v_cvt_pk_f16_f32 v191, v163, v167
    v_mfma_f32_16x16x32_f16 v[160:163], v[248:251], v[20:23], 0
    s_waitcnt lgkmcnt(11)
    ds_read_b128 v[248:251], v2 offset:2976
    v_mfma_f32_16x16x32_f16 v[164:167], v[4:7], v[16:19], 0
    s_waitcnt lgkmcnt(11)
    v_cvt_pk_f16_f32 v192, v168, v172
    v_cvt_pk_f16_f32 v193, v169, v173
    v_mfma_f32_16x16x32_f16 v[152:155], v[96:99], v[224:227], v[152:155]
    v_cvt_pk_f16_f32 v194, v170, v174
    v_cvt_pk_f16_f32 v195, v171, v175
    v_mfma_f32_16x16x32_f16 v[152:155], v[176:179], v[104:107], v[152:155]
    s_waitcnt lgkmcnt(10)
    v_cvt_pk_f16_f32 v196, v160, v164
    v_cvt_pk_f16_f32 v197, v161, v165
    v_mfma_f32_16x16x32_f16 v[152:155], v[92:95], v[228:231], v[152:155]
    v_cvt_pk_f16_f32 v198, v162, v166
    v_cvt_pk_f16_f32 v199, v163, v167
    v_mfma_f32_16x16x32_f16 v[152:155], v[180:183], v[116:119], v[152:155]
    s_waitcnt lgkmcnt(4)
    ds_read_b128 v[4:7], v2 offset:3040
    ds_read_b128 v[224:227], v2 offset:3104
    v_mfma_f32_16x16x32_f16 v[152:155], v[88:91], v[232:235], v[152:155]
    s_waitcnt lgkmcnt(5)
    ds_read_b128 v[228:231], v2 offset:3168
    v_mfma_f32_16x16x32_f16 v[152:155], v[84:87], v[236:239], v[152:155]
    ds_read_b128 v[232:235], v2 offset:3232
    v_mfma_f32_16x16x32_f16 v[152:155], v[216:219], v[128:131], v[152:155]
    s_waitcnt lgkmcnt(6)
    ds_read_b128 v[236:239], v2 offset:3296
    v_mfma_f32_16x16x32_f16 v[152:155], v[80:83], v[240:243], v[152:155]
    ds_read_b128 v[240:243], v2 offset:2016
    v_mfma_f32_16x16x32_f16 v[152:155], v[184:187], v[108:111], v[152:155]
    s_waitcnt lgkmcnt(7)
    v_mfma_f32_16x16x32_f16 v[152:155], v[76:79], v[244:247], v[152:155]
    ds_read_b128 v[244:247], v2 offset:2000
    v_mfma_f32_16x16x32_f16 v[152:155], v[188:191], v[120:123], v[152:155]
    s_waitcnt lgkmcnt(7)
    v_mfma_f32_16x16x32_f16 v[152:155], v[72:75], v[248:251], v[152:155]
    s_waitcnt lgkmcnt(6)
    ds_read_b128 v[248:251], v2 offset:3360
    v_mfma_f32_16x16x32_f16 v[152:155], v[68:71], v[4:7], v[152:155]
    s_waitcnt lgkmcnt(6)
    ds_read_b128 v[4:7], v2 offset:3424
    v_mfma_f32_16x16x32_f16 v[152:155], v[64:67], v[224:227], v[152:155]
    ds_read_b128 v[224:227], v2 offset:3488
    v_mfma_f32_16x16x32_f16 v[152:155], v[192:195], v[112:115], v[152:155]
    s_waitcnt lgkmcnt(7)
    v_mfma_f32_16x16x32_f16 v[152:155], v[60:63], v[228:231], v[152:155]
    s_waitcnt lgkmcnt(6)
    ds_read_b128 v[228:231], v2 offset:3552
    v_mfma_f32_16x16x32_f16 v[152:155], v[56:59], v[232:235], v[152:155]
    ds_read_b128 v[232:235], v2 offset:3040
    v_mfma_f32_16x16x32_f16 v[152:155], v[196:199], v[124:127], v[152:155]
    s_waitcnt lgkmcnt(7)
    v_mfma_f32_16x16x32_f16 v[152:155], v[52:55], v[236:239], v[152:155]
    s_waitcnt lgkmcnt(6)
    ds_read_b128 v[236:239], v2 offset:3024
    v_mfma_f32_16x16x32_f16 v[168:171], v[240:243], v[24:27], 0
    s_waitcnt lgkmcnt(6)
    ds_read_b128 v[240:243], v2 offset:3104
    v_mfma_f32_16x16x32_f16 v[172:175], v[244:247], v[28:31], 0
    s_waitcnt lgkmcnt(6)
    ds_read_b128 v[244:247], v2 offset:3168
    v_mfma_f32_16x16x32_f16 v[152:155], v[48:51], v[248:251], v[152:155]
    s_waitcnt lgkmcnt(6)
    ds_read_b128 v[248:251], v2 offset:3232
    v_mfma_f32_16x16x32_f16 v[152:155], v[44:47], v[4:7], v[152:155]
    s_waitcnt lgkmcnt(6)
    ds_read_b128 v[4:7], v2 offset:3296
    v_mfma_f32_16x16x32_f16 v[152:155], v[40:43], v[224:227], v[152:155]
    s_waitcnt lgkmcnt(6)
    v_cvt_pk_f16_f32 v220, v168, v172
    v_cvt_pk_f16_f32 v221, v169, v173
    v_mfma_f32_16x16x32_f16 v[152:155], v[36:39], v[228:231], v[152:155]
    s_waitcnt lgkmcnt(5)
    v_cvt_pk_f16_f32 v222, v170, v174
    v_cvt_pk_f16_f32 v223, v171, v175
    v_mfma_f32_16x16x32_f16 v[156:159], v[100:103], v[232:235], v[156:159]
    ds_read_b128 v[224:227], v2 offset:3360
    v_mfma_f32_16x16x32_f16 v[160:163], v[232:235], v[12:15], 0
    ds_read_b128 v[228:231], v2 offset:3424
    v_mfma_f32_16x16x32_f16 v[164:167], v[232:235], v[16:19], 0
    ds_write_addtid_b32 v152 offset:2112
    ds_write_addtid_b32 v153 offset:2376
    v_mfma_f32_16x16x32_f16 v[168:171], v[232:235], v[20:23], 0
    s_waitcnt lgkmcnt(8)
    ds_write_addtid_b32 v154 offset:2640
    ds_write_addtid_b32 v155 offset:2904
    v_mfma_f32_16x16x32_f16 v[172:175], v[236:239], v[16:19], 0
    s_waitcnt lgkmcnt(9)
    ds_write_b8 v3, v252 offset:40
    v_cvt_pk_f16_f32 v200, v160, v164
    v_mfma_f32_16x16x32_f16 v[156:159], v[96:99], v[240:243], v[156:159]
    v_cvt_pk_f16_f32 v201, v161, v165
    v_cvt_pk_f16_f32 v202, v162, v166
    v_mfma_f32_16x16x32_f16 v[156:159], v[208:211], v[140:143], v[156:159]
    s_waitcnt lgkmcnt(9)
    v_cvt_pk_f16_f32 v203, v163, v167
    v_cvt_pk_f16_f32 v204, v168, v172
    v_mfma_f32_16x16x32_f16 v[156:159], v[92:95], v[244:247], v[156:159]
    v_cvt_pk_f16_f32 v205, v169, v173
    v_cvt_pk_f16_f32 v206, v170, v174
    v_mfma_f32_16x16x32_f16 v[156:159], v[212:215], v[136:139], v[156:159]
    s_waitcnt lgkmcnt(8)
    ds_read_b128 v[232:235], v2 offset:3488
    v_cvt_pk_f16_f32 v207, v171, v175
    v_mfma_f32_16x16x32_f16 v[156:159], v[88:91], v[248:251], v[156:159]
    ds_read_b128 v[236:239], v2 offset:3552
    v_mfma_f32_16x16x32_f16 v[156:159], v[216:219], v[132:135], v[156:159]
    s_waitcnt lgkmcnt(9)
    ds_read_b128 v[240:243], v2 offset:3616
    v_mfma_f32_16x16x32_f16 v[156:159], v[84:87], v[4:7], v[156:159]
    ds_read_b128 v[244:247], v2 offset:3680
    v_mfma_f32_16x16x32_f16 v[156:159], v[184:187], v[104:107], v[156:159]
    s_waitcnt lgkmcnt(10)
    ds_read_b128 v[248:251], v2 offset:3744
    v_mfma_f32_16x16x32_f16 v[156:159], v[80:83], v[224:227], v[156:159]
    ds_read_b128 v[4:7], v2 offset:3808
    v_mfma_f32_16x16x32_f16 v[156:159], v[188:191], v[116:119], v[156:159]
    s_waitcnt lgkmcnt(11)
    ds_read_b128 v[224:227], v2 offset:3872
    v_mfma_f32_16x16x32_f16 v[156:159], v[76:79], v[228:231], v[156:159]
    ds_read_b128 v[228:231], v2 offset:3936
    v_mfma_f32_16x16x32_f16 v[156:159], v[192:195], v[108:111], v[156:159]
    s_waitcnt lgkmcnt(7)
    v_mfma_f32_16x16x32_f16 v[156:159], v[72:75], v[232:235], v[156:159]
    ds_read_b128 v[232:235], v2 offset:4000
    v_mfma_f32_16x16x32_f16 v[156:159], v[196:199], v[120:123], v[156:159]
    s_waitcnt lgkmcnt(7)
    v_mfma_f32_16x16x32_f16 v[156:159], v[68:71], v[236:239], v[156:159]
    ds_read_b128 v[236:239], v2 offset:4064
    v_mfma_f32_16x16x32_f16 v[156:159], v[220:223], v[128:131], v[156:159]
    s_waitcnt lgkmcnt(7)
    v_mfma_f32_16x16x32_f16 v[156:159], v[64:67], v[240:243], v[156:159]
    s_waitcnt lgkmcnt(6)
    v_mfma_f32_16x16x32_f16 v[156:159], v[60:63], v[244:247], v[156:159]
    v_mfma_f32_16x16x32_f16 v[156:159], v[200:203], v[112:115], v[156:159]
    s_waitcnt lgkmcnt(5)
    v_mfma_f32_16x16x32_f16 v[156:159], v[56:59], v[248:251], v[156:159]
    s_waitcnt lgkmcnt(4)
    v_mfma_f32_16x16x32_f16 v[156:159], v[52:55], v[4:7], v[156:159]
    v_mfma_f32_16x16x32_f16 v[156:159], v[204:207], v[124:127], v[156:159]
    s_waitcnt lgkmcnt(3)
    v_mfma_f32_16x16x32_f16 v[156:159], v[48:51], v[224:227], v[156:159]
    s_waitcnt lgkmcnt(2)
    v_mfma_f32_16x16x32_f16 v[156:159], v[44:47], v[228:231], v[156:159]
    s_waitcnt lgkmcnt(1)
    v_mfma_f32_16x16x32_f16 v[156:159], v[40:43], v[232:235], v[156:159]
    s_waitcnt lgkmcnt(0)
    v_mfma_f32_16x16x32_f16 v[156:159], v[36:39], v[236:239], v[156:159]
    s_nop 7
    ds_write_addtid_b32 v156 offset:3168
    ds_write_addtid_b32 v157 offset:3432
    ds_write_addtid_b32 v158 offset:3696
    ds_write_addtid_b32 v159 offset:3960
    ds_write_b8 v3, v252 offset:44
    s_endpgm
.p2align 3
L_convY:
    s_waitcnt lgkmcnt(0)
    s_mov_b32 s53, 0
spin_33:
    ds_read_b32 v144, v10 offset:20
    s_waitcnt lgkmcnt(0)
    v_readfirstlane_b32 s52, v144
    s_add_u32 s53, s53, 1
    s_cmp_eq_u32 s52, 257
    s_cbranch_scc1 spun_34
    s_cmp_lt_u32 s53, 3200000
    s_sleep 1
    s_cbranch_scc1 spin_33
spun_34:
    ds_read_b128 v[224:227], v2 offset:480
    ds_read_b128 v[228:231], v2 offset:464
    ds_read_b128 v[232:235], v2 offset:544
    s_waitcnt lgkmcnt(2)
    ds_read_b128 v[236:239], v2 offset:608
    ds_read_b128 v[240:243], v2 offset:672
    v_mfma_f32_16x16x32_f16 v[144:147], v[100:103], v[224:227], 0
    ds_read_b128 v[244:247], v2 offset:736
    ds_read_b64 v[112:113], v253 offset:128
    v_mfma_f32_16x16x32_f16 v[160:163], v[224:227], v[12:15], 0
    ds_read_b128 v[248:251], v2 offset:800
    ds_read_b64 v[114:115], v253 offset:136
    v_mfma_f32_16x16x32_f16 v[164:167], v[224:227], v[16:19], 0
    ds_read_b128 v[4:7], v2 offset:864
    ds_read_b128 v[216:219], v2 offset:928
    v_mfma_f32_16x16x32_f16 v[168:171], v[224:227], v[20:23], 0
    s_waitcnt lgkmcnt(9)
    ds_read_b128 v[220:223], v2 offset:992
    ds_read_b64 v[124:125], v253 offset:384
    v_mfma_f32_16x16x32_f16 v[172:175], v[228:231], v[16:19], 0
    s_waitcnt lgkmcnt(10)
    ds_read_b64 v[126:127], v253 offset:392
    v_cvt_pk_f16_f32 v176, v160, v164
    v_mfma_f32_16x16x32_f16 v[144:147], v[96:99], v[232:235], v[144:147]
    s_waitcnt lgkmcnt(10)
    ds_read_b128 v[136:139], v2 offset:1056
    v_cvt_pk_f16_f32 v177, v161, v165
    v_mfma_f32_16x16x32_f16 v[144:147], v[92:95], v[236:239], v[144:147]
    s_waitcnt lgkmcnt(10)
    ds_read_b128 v[140:143], v2 offset:1120
    v_cvt_pk_f16_f32 v178, v162, v166
    v_mfma_f32_16x16x32_f16 v[144:147], v[88:91], v[240:243], v[144:147]
    s_waitcnt lgkmcnt(10)
    v_cvt_pk_f16_f32 v179, v163, v167
    v_cvt_pk_f16_f32 v180, v168, v172
    v_mfma_f32_16x16x32_f16 v[144:147], v[84:87], v[244:247], v[144:147]
    s_waitcnt lgkmcnt(8)
    ds_read_b128 v[224:227], v2 offset:1184
    v_cvt_pk_f16_f32 v181, v169, v173
    v_mfma_f32_16x16x32_f16 v[144:147], v[80:83], v[248:251], v[144:147]
    s_waitcnt lgkmcnt(7)
    ds_read_b128 v[228:231], v2 offset:1248
    v_cvt_pk_f16_f32 v182, v170, v174
    v_mfma_f32_16x16x32_f16 v[144:147], v[76:79], v[4:7], v[144:147]
    s_waitcnt lgkmcnt(7)
    ds_read_b128 v[232:235], v2 offset:1312
    v_cvt_pk_f16_f32 v183, v171, v175
    v_mfma_f32_16x16x32_f16 v[144:147], v[72:75], v[216:219], v[144:147]
    s_waitcnt lgkmcnt(7)
    ds_read_b128 v[236:239], v2 offset:1376
    ds_read_b128 v[240:243], v2 offset:1440
    v_mfma_f32_16x16x32_f16 v[144:147], v[68:71], v[220:223], v[144:147]
    ds_read_b128 v[244:247], v2 offset:1504
    ds_read_b64 v[108:109], v253 offset:64
    v_mfma_f32_16x16x32_f16 v[144:147], v[176:179], v[112:115], v[144:147]
    s_waitcnt lgkmcnt(8)
    ds_read_b128 v[248:251], v2 offset:992
    ds_read_b64 v[110:111], v253 offset:72
    v_mfma_f32_16x16x32_f16 v[144:147], v[64:67], v[136:139], v[144:147]
    s_waitcnt lgkmcnt(9)
    ds_read_b128 v[4:7], v2 offset:976
    ds_read_b64 v[120:121], v253 offset:320
    v_mfma_f32_16x16x32_f16 v[144:147], v[60:63], v[140:143], v[144:147]
    ds_read_b128 v[216:219], v2 offset:1056
    ds_read_b64 v[122:123], v253 offset:328
    v_mfma_f32_16x16x32_f16 v[144:147], v[180:183], v[124:127], v[144:147]
    s_waitcnt lgkmcnt(12)
    ds_read_b128 v[220:223], v2 offset:1120
    ds_read_b64 v[104:105], v253 offset:0
    v_mfma_f32_16x16x32_f16 v[144:147], v[56:59], v[224:227], v[144:147]
    s_waitcnt lgkmcnt(13)
    ds_read_b128 v[136:139], v2 offset:1184
    ds_read_b64 v[106:107], v253 offset:8
    v_mfma_f32_16x16x32_f16 v[144:147], v[52:55], v[228:231], v[144:147]
    s_waitcnt lgkmcnt(14)
    ds_read_b128 v[140:143], v2 offset:1248
    ds_read_b64 v[116:117], v253 offset:256
    v_mfma_f32_16x16x32_f16 v[144:147], v[48:51], v[232:235], v[144:147]
    s_waitcnt lgkmcnt(15)
    ds_read_b128 v[224:227], v2 offset:1312
    ds_read_b64 v[118:119], v253 offset:264
    v_mfma_f32_16x16x32_f16 v[144:147], v[44:47], v[236:239], v[144:147]
    s_waitcnt lgkmcnt(15)
    ds_read_b128 v[228:231], v2 offset:1376
    ds_read_b64 v[128:129], v253 offset:704
    v_mfma_f32_16x16x32_f16 v[144:147], v[40:43], v[240:243], v[144:147]
    ds_read_b128 v[232:235], v2 offset:1440
    ds_read_b64 v[130:131], v253 offset:712
    v_mfma_f32_16x16x32_f16 v[144:147], v[36:39], v[244:247], v[144:147]
    s_waitcnt lgkmcnt(15)
    ds_read_b128 v[236:239], v2 offset:1504
    ds_read_b64 v[132:133], v253 offset:640
    v_mfma_f32_16x16x32_f16 v[148:151], v[100:103], v[248:251], 0
    ds_read_b128 v[240:243], v2 offset:1568
    ds_read_b64 v[134:135], v253 offset:648
    v_mfma_f32_16x16x32_f16 v[160:163], v[248:251], v[12:15], 0
    ds_read_b128 v[244:247], v2 offset:1632
    v_mfma_f32_16x16x32_f16 v[164:167], v[248:251], v[16:19], 0
    ds_write_addtid_b32 v144 offset:0
    ds_write_addtid_b32 v145 offset:264
    v_mfma_f32_16x16x32_f16 v[168:171], v[248:251], v[20:23], 0
    ds_write_addtid_b32 v146 offset:528
    ds_write_addtid_b32 v147 offset:792
    v_mfma_f32_16x16x32_f16 v[172:175], v[4:7], v[16:19], 0
    s_waitcnt lgkmcnt(15)
    ds_write_b8 v3, v252 offset:32
    v_cvt_pk_f16_f32 v184, v160, v164
    v_mfma_f32_16x16x32_f16 v[148:151], v[96:99], v[216:219], v[148:151]
    v_cvt_pk_f16_f32 v185, v161, v165
    v_cvt_pk_f16_f32 v186, v162, v166
    v_mfma_f32_16x16x32_f16 v[148:151], v[92:95], v[220:223], v[148:151]
    v_cvt_pk_f16_f32 v187, v163, v167
    v_cvt_pk_f16_f32 v188, v168, v172
    v_mfma_f32_16x16x32_f16 v[148:151], v[176:179], v[108:111], v[148:151]
    v_cvt_pk_f16_f32 v189, v169, v173
    v_cvt_pk_f16_f32 v190, v170, v174
    v_mfma_f32_16x16x32_f16 v[148:151], v[88:91], v[136:139], v[148:151]
    v_cvt_pk_f16_f32 v191, v171, v175
    v_mfma_f32_16x16x32_f16 v[148:151], v[84:87], v[140:143], v[148:151]
    ds_read_b128 v[248:251], v2 offset:1696
    v_mfma_f32_16x16x32_f16 v[148:151], v[180:183], v[120:123], v[148:151]
    s_waitcnt lgkmcnt(15)
    ds_read_b128 v[4:7], v2 offset:1760
    v_mfma_f32_16x16x32_f16 v[148:151], v[80:83], v[224:227], v[148:151]
    s_waitcnt lgkmcnt(15)
    ds_read_b128 v[216:219], v2 offset:480
    v_mfma_f32_16x16x32_f16 v[148:151], v[76:79], v[228:231], v[148:151]
    s_waitcnt lgkmcnt(14)
    ds_read_b128 v[220:223], v2 offset:464
    v_mfma_f32_16x16x32_f16 v[148:151], v[72:75], v[232:235], v[148:151]
    s_waitcnt lgkmcnt(13)
    ds_read_b128 v[136:139], v2 offset:1824
    v_mfma_f32_16x16x32_f16 v[148:151], v[68:71], v[236:239], v[148:151]
    ds_read_b128 v[140:143], v2 offset:1888
    v_mfma_f32_16x16x32_f16 v[148:151], v[184:187], v[112:115], v[148:151]
    s_waitcnt lgkmcnt(13)
    ds_read_b128 v[224:227], v2 offset:1952
    v_mfma_f32_16x16x32_f16 v[148:151], v[64:67], v[240:243], v[148:151]
    s_waitcnt lgkmcnt(12)
    ds_read_b128 v[228:231], v2 offset:2016
    v_mfma_f32_16x16x32_f16 v[148:151], v[60:63], v[244:247], v[148:151]
    ds_read_b128 v[232:235], v2 offset:1504
    v_mfma_f32_16x16x32_f16 v[148:151], v[188:191], v[124:127], v[148:151]
    s_waitcnt lgkmcnt(8)
    ds_read_b128 v[236:239], v2 offset:1488
    v_mfma_f32_16x16x32_f16 v[148:151], v[56:59], v[248:251], v[148:151]
    s_waitcnt lgkmcnt(8)
    ds_read_b128 v[240:243], v2 offset:1568
    v_mfma_f32_16x16x32_f16 v[148:151], v[52:55], v[4:7], v[148:151]
    s_waitcnt lgkmcnt(8)
    ds_read_b128 v[244:247], v2 offset:1632
    v_mfma_f32_16x16x32_f16 v[160:163], v[216:219], v[24:27], 0
    s_waitcnt lgkmcnt(8)
    ds_read_b128 v[248:251], v2 offset:1696
    v_mfma_f32_16x16x32_f16 v[164:167], v[220:223], v[28:31], 0
    ds_read_b128 v[4:7], v2 offset:1760
    v_mfma_f32_16x16x32_f16 v[152:155], v[32:35], v[216:219], 0
    s_waitcnt lgkmcnt(9)
    ds_read_b128 v[220:223], v2 offset:1824
    v_mfma_f32_16x16x32_f16 v[148:151], v[48:51], v[136:139], v[148:151]
    s_waitcnt lgkmcnt(9)
    ds_read_b128 v[216:219], v2 offset:1888
    v_mfma_f32_16x16x32_f16 v[148:151], v[44:47], v[140:143], v[148:151]
    s_waitcnt lgkmcnt(9)
    v_cvt_pk_f16_f32 v208, v160, v164
    v_cvt_pk_f16_f32 v209, v161, v165
    v_mfma_f32_16x16x32_f16 v[148:151], v[40:43], v[224:227], v[148:151]
    s_waitcnt lgkmcnt(8)
    v_cvt_pk_f16_f32 v210, v162, v166
    v_cvt_pk_f16_f32 v211, v163, v167
    v_mfma_f32_16x16x32_f16 v[148:151], v[36:39], v[228:231], v[148:151]
    s_waitcnt lgkmcnt(7)
    ds_read_b128 v[136:139], v2 offset:1952
    v_mfma_f32_16x16x32_f16 v[152:155], v[100:103], v[232:235], v[152:155]
    ds_read_b128 v[140:143], v2 offset:2016
    v_mfma_f32_16x16x32_f16 v[168:171], v[232:235], v[12:15], 0
    ds_read_b128 v[224:227], v2 offset:2080
    v_mfma_f32_16x16x32_f16 v[172:175], v[232:235], v[16:19], 0
    ds_read_b128 v[228:231], v2 offset:2144
    v_mfma_f32_16x16x32_f16 v[160:163], v[232:235], v[20:23], 0
    s_waitcnt lgkmcnt(10)
    ds_write_addtid_b32 v148 offset:1056
    ds_write_addtid_b32 v149 offset:1320
    v_mfma_f32_16x16x32_f16 v[164:167], v[236:239], v[16:19], 0
    s_waitcnt lgkmcnt(11)
    ds_write_addtid_b32 v150 offset:1584
    ds_write_addtid_b32 v151 offset:1848
    v_mfma_f32_16x16x32_f16 v[152:155], v[96:99], v[240:243], v[152:155]
    ds_write_b8 v3, v252 offset:36
    v_cvt_pk_f16_f32 v192, v168, v172
    v_mfma_f32_16x16x32_f16 v[152:155], v[176:179], v[104:107], v[152:155]
    s_waitcnt lgkmcnt(13)
    v_cvt_pk_f16_f32 v193, v169, v173
    v_cvt_pk_f16_f32 v194, v170, v174
    v_mfma_f32_16x16x32_f16 v[152:155], v[92:95], v[244:247], v[152:155]
    v_cvt_pk_f16_f32 v195, v171, v175
    v_cvt_pk_f16_f32 v196, v160, v164
    v_mfma_f32_16x16x32_f16 v[152:155], v[180:183], v[116:119], v[152:155]
    s_waitcnt lgkmcnt(12)
    v_cvt_pk_f16_f32 v197, v161, v165
    v_cvt_pk_f16_f32 v198, v162, v166
    v_mfma_f32_16x16x32_f16 v[152:155], v[88:91], v[248:251], v[152:155]
    s_waitcnt lgkmcnt(11)
    v_cvt_pk_f16_f32 v199, v163, v167
    v_mfma_f32_16x16x32_f16 v[152:155], v[84:87], v[4:7], v[152:155]
    ds_read_b128 v[232:235], v2 offset:2208
    v_mfma_f32_16x16x32_f16 v[152:155], v[184:187], v[108:111], v[152:155]
    s_waitcnt lgkmcnt(11)
    ds_read_b128 v[236:239], v2 offset:2272
    v_mfma_f32_16x16x32_f16 v[152:155], v[80:83], v[220:223], v[152:155]
    s_waitcnt lgkmcnt(11)
    ds_read_b128 v[240:243], v2 offset:992
    v_mfma_f32_16x16x32_f16 v[152:155], v[76:79], v[216:219], v[152:155]
    ds_read_b128 v[244:247], v2 offset:976
    v_mfma_f32_16x16x32_f16 v[152:155], v[188:191], v[120:123], v[152:155]
    s_waitcnt lgkmcnt(12)
    ds_read_b128 v[248:251], v2 offset:2336
    v_mfma_f32_16x16x32_f16 v[152:155], v[72:75], v[136:139], v[152:155]
    s_waitcnt lgkmcnt(12)
    ds_read_b128 v[4:7], v2 offset:2400
    v_mfma_f32_16x16x32_f16 v[152:155], v[68:71], v[140:143], v[152:155]
    ds_read_b128 v[220:223], v2 offset:2464
    v_mfma_f32_16x16x32_f16 v[152:155], v[208:211], v[128:131], v[152:155]
    s_waitcnt lgkmcnt(13)
    ds_read_b128 v[216:219], v2 offset:2528
    v_mfma_f32_16x16x32_f16 v[152:155], v[64:67], v[224:227], v[152:155]
    s_waitcnt lgkmcnt(13)
    ds_read_b128 v[136:139], v2 offset:2016
    v_mfma_f32_16x16x32_f16 v[152:155], v[60:63], v[228:231], v[152:155]
    ds_read_b128 v[140:143], v2 offset:2000
    v_mfma_f32_16x16x32_f16 v[152:155], v[192:195], v[112:115], v[152:155]
    s_waitcnt lgkmcnt(9)
    ds_read_b128 v[224:227], v2 offset:2080
    v_mfma_f32_16x16x32_f16 v[152:155], v[56:59], v[232:235], v[152:155]
    ds_read_b128 v[228:231], v2 offset:2144
    v_mfma_f32_16x16x32_f16 v[152:155], v[196:199], v[124:127], v[152:155]
    s_waitcnt lgkmcnt(10)
    ds_read_b128 v[232:235], v2 offset:2208
    v_mfma_f32_16x16x32_f16 v[152:155], v[52:55], v[236:239], v[152:155]
    s_waitcnt lgkmcnt(10)
    ds_read_b128 v[236:239], v2 offset:2272
    v_mfma_f32_16x16x32_f16 v[168:171], v[240:243], v[24:27], 0
    s_waitcnt lgkmcnt(10)
    v_mfma_f32_16x16x32_f16 v[172:175], v[244:247], v[28:31], 0
    ds_read_b128 v[244:247], v2 offset:2336
    v_mfma_f32_16x16x32_f16 v[156:159], v[32:35], v[240:243], 0
    s_waitcnt lgkmcnt(10)
    ds_read_b128 v[240:243], v2 offset:2400
    v_mfma_f32_16x16x32_f16 v[152:155], v[48:51], v[248:251], v[152:155]
    s_waitcnt lgkmcnt(10)
    ds_read_b128 v[248:251], v2 offset:2464
    v_mfma_f32_16x16x32_f16 v[152:155], v[44:47], v[4:7], v[152:155]
    s_waitcnt lgkmcnt(10)
    v_cvt_pk_f16_f32 v212, v168, v172
    v_cvt_pk_f16_f32 v213, v169, v173
    v_mfma_f32_16x16x32_f16 v[152:155], v[40:43], v[220:223], v[152:155]
    s_waitcnt lgkmcnt(9)
    v_cvt_pk_f16_f32 v214, v170, v174
    v_cvt_pk_f16_f32 v215, v171, v175
    v_mfma_f32_16x16x32_f16 v[152:155], v[36:39], v[216:219], v[152:155]
    s_waitcnt lgkmcnt(8)
    ds_read_b128 v[4:7], v2 offset:2528
    v_mfma_f32_16x16x32_f16 v[156:159], v[100:103], v[136:139], v[156:159]
    ds_read_b128 v[220:223], v2 offset:2592
    v_mfma_f32_16x16x32_f16 v[160:163], v[136:139], v[12:15], 0
    ds_read_b128 v[216:219], v2 offset:2656
    v_mfma_f32_16x16x32_f16 v[164:167], v[136:139], v[16:19], 0
    v_mfma_f32_16x16x32_f16 v[168:171], v[136:139], v[20:23], 0
    s_waitcnt lgkmcnt(10)
    ds_write_addtid_b32 v152 offset:2112
    ds_write_addtid_b32 v153 offset:2376
    v_mfma_f32_16x16x32_f16 v[172:175], v[140:143], v[16:19], 0
    s_waitcnt lgkmcnt(11)
    ds_write_addtid_b32 v154 offset:2640
    ds_write_addtid_b32 v155 offset:2904
    v_mfma_f32_16x16x32_f16 v[156:159], v[96:99], v[224:227], v[156:159]
    ds_write_b8 v3, v252 offset:40
    v_cvt_pk_f16_f32 v200, v160, v164
    v_mfma_f32_16x16x32_f16 v[156:159], v[184:187], v[104:107], v[156:159]
    s_waitcnt lgkmcnt(13)
    v_cvt_pk_f16_f32 v201, v161, v165
    v_cvt_pk_f16_f32 v202, v162, v166
    v_mfma_f32_16x16x32_f16 v[156:159], v[92:95], v[228:231], v[156:159]
    v_cvt_pk_f16_f32 v203, v163, v167
    v_cvt_pk_f16_f32 v204, v168, v172
    v_mfma_f32_16x16x32_f16 v[156:159], v[188:191], v[116:119], v[156:159]
    s_waitcnt lgkmcnt(12)
    v_cvt_pk_f16_f32 v205, v169, v173
    v_cvt_pk_f16_f32 v206, v170, v174
    v_mfma_f32_16x16x32_f16 v[156:159], v[88:91], v[232:235], v[156:159]
    s_waitcnt lgkmcnt(11)
    v_cvt_pk_f16_f32 v207, v171, v175
    v_mfma_f32_16x16x32_f16 v[156:159], v[84:87], v[236:239], v[156:159]
    ds_read_b128 v[136:139], v2 offset:2720
    v_mfma_f32_16x16x32_f16 v[156:159], v[192:195], v[108:111], v[156:159]
    s_waitcnt lgkmcnt(11)
    ds_read_b128 v[140:143], v2 offset:2784
    v_mfma_f32_16x16x32_f16 v[156:159], v[80:83], v[244:247], v[156:159]
    s_waitcnt lgkmcnt(11)
    ds_read_b128 v[224:227], v2 offset:2848
    v_mfma_f32_16x16x32_f16 v[156:159], v[76:79], v[240:243], v[156:159]
    ds_read_b128 v[228:231], v2 offset:2912
    v_mfma_f32_16x16x32_f16 v[156:159], v[196:199], v[120:123], v[156:159]
    s_waitcnt lgkmcnt(12)
    ds_read_b128 v[232:235], v2 offset:2976
    v_mfma_f32_16x16x32_f16 v[156:159], v[72:75], v[248:251], v[156:159]
    s_waitcnt lgkmcnt(12)
    ds_read_b128 v[236:239], v2 offset:3040
    v_mfma_f32_16x16x32_f16 v[156:159], v[68:71], v[4:7], v[156:159]
    v_mfma_f32_16x16x32_f16 v[156:159], v[208:211], v[132:135], v[156:159]
    s_waitcnt lgkmcnt(12)
    v_mfma_f32_16x16x32_f16 v[156:159], v[64:67], v[220:223], v[156:159]
    v_mfma_f32_16x16x32_f16 v[156:159], v[212:215], v[128:131], v[156:159]
    s_waitcnt lgkmcnt(11)
    v_mfma_f32_16x16x32_f16 v[156:159], v[60:63], v[216:219], v[156:159]
    s_waitcnt lgkmcnt(5)
    v_mfma_f32_16x16x32_f16 v[156:159], v[56:59], v[136:139], v[156:159]
    v_mfma_f32_16x16x32_f16 v[156:159], v[200:203], v[112:115], v[156:159]
    s_waitcnt lgkmcnt(4)
    v_mfma_f32_16x16x32_f16 v[156:159], v[52:55], v[140:143], v[156:159]
    s_waitcnt lgkmcnt(3)
    v_mfma_f32_16x16x32_f16 v[156:159], v[48:51], v[224:227], v[156:159]
    v_mfma_f32_16x16x32_f16 v[156:159], v[204:207], v[124:127], v[156:159]
    s_waitcnt lgkmcnt(2)
    v_mfma_f32_16x16x32_f16 v[156:159], v[44:47], v[228:231], v[156:159]
    s_waitcnt lgkmcnt(1)
    v_mfma_f32_16x16x32_f16 v[156:159], v[40:43], v[232:235], v[156:159]
    s_waitcnt lgkmcnt(0)
    v_mfma_f32_16x16x32_f16 v[156:159], v[36:39], v[236:239], v[156:159]
    s_nop 7
    ds_write_addtid_b32 v156 offset:3168
    ds_write_addtid_b32 v157 offset:3432
    ds_write_addtid_b32 v158 offset:3696
    ds_write_addtid_b32 v159 offset:3960
    ds_write_b8 v3, v252 offset:44
    s_endpgm
L_exit:
    s_endpgm
.p2align 7
L_tab:
    .long 0x0, 0x0, 0x0, 0x0
    .long 0x0, 0x0, 0x0, 0x0
    .long 0x0, 0x0, 0x0, 0x0
    .long 0x0, 0x0, 0x0, 0x0
    .long 0x0, 0x0, 0x0, 0x0
    .long 0x0, 0x0, 0x0, 0x0
    .long 0x0, 0x0, 0x0, 0x0
    .long 0x0, 0x0, 0x0, 0x0
    .long 0x0, 0x0, 0x0, 0x0
    .long 0x0, 0x0, 0x0, 0x0
    .long 0x0, 0x0, 0x0, 0x0
    .long 0x0, 0x0, 0x0, 0x0
    .long 0x0, 0x0, 0x0, 0x0
    .long 0x0, 0x0, 0x0, 0x0
    .long 0x0, 0x0, 0x0, 0x0
    .long 0x0, 0x0, 0x0, 0x0
    .long 0x0, 0x3c000000, 0x3c003c00, 0x0
    .long 0x0, 0x0, 0x3c003c00, 0x3c00
    .long 0x0, 0x0, 0x3c000000, 0x3c003c00
    .long 0x0, 0x0, 0x0, 0x3c003c00
    .long 0x0, 0x0, 0x0, 0x3c000000
    .long 0x0, 0x0, 0x0, 0x0
    .long 0x0, 0x0, 0x0, 0x0
    .long 0x0, 0x0, 0x0, 0x0
    .long 0x0, 0x0, 0x0, 0x0
    .long 0x0, 0x0, 0x0, 0x0
    .long 0x0, 0x0, 0x0, 0x0
    .long 0x0, 0x0, 0x0, 0x0
    .long 0x0, 0x0, 0x0, 0x0
    .long 0x0, 0x0, 0x0, 0x0
    .long 0x0, 0x0, 0x0, 0x0
    .long 0x0, 0x0, 0x0, 0x0
    .long 0x0, 0x0, 0x0, 0x0
    .long 0x0, 0x0, 0x0, 0x0
    .long 0x0, 0x0, 0x0, 0x0
    .long 0x3c00, 0x0, 0x0, 0x0
    .long 0x3c003c00, 0x0, 0x0, 0x0
    .long 0x3c003c00, 0x3c00, 0x0, 0x0
    .long 0x3c000000, 0x3c003c00, 0x0, 0x0
    .long 0x0, 0x3c003c00, 0x3c00, 0x0
    .long 0x0, 0x3c000000, 0x3c003c00, 0x0
    .long 0x0, 0x0, 0x3c003c00, 0x3c00
    .long 0x0, 0x0, 0x3c000000, 0x3c003c00
    .long 0x0, 0x0, 0x0, 0x3c003c00
    .long 0x0, 0x0, 0x0, 0x3c000000
    .long 0x0, 0x0, 0x0, 0x0
    .long 0x0, 0x0, 0x0, 0x0
    .long 0x0, 0x0, 0x0, 0x0
    .long 0x0, 0x0, 0x0, 0x0
    .long 0x0, 0x0, 0x0, 0x0
    .long 0x0, 0x0, 0x0, 0x0
    .long 0x0, 0x0, 0x0, 0x0
    .long 0x0, 0x0, 0x0, 0x0
    .long 0x0, 0x0, 0x0, 0x0
    .long 0x0, 0x0, 0x0, 0x0
    .long 0x0, 0x0, 0x0, 0x0
    .long 0x0, 0x0, 0x0, 0x0
    .long 0x0, 0x0, 0x0, 0x0
    .long 0x0, 0x0, 0x0, 0x0
    .long 0x3c00, 0x0, 0x0, 0x0
    .long 0x3c003c00, 0x0, 0x0, 0x0
    .long 0x3c003c00, 0x3c00, 0x0, 0x0
    .long 0x3c000000, 0x3c003c00, 0x0, 0x0
    .long 0x0, 0x3c003c00, 0x3c00, 0x0
    .long 0x0, 0x0, 0x0, 0x3c003c00
    .long 0x0, 0x0, 0x0, 0x3c000000
    .long 0x0, 0x0, 0x0, 0x0
    .long 0x0, 0x0, 0x0, 0x0
    .long 0x0, 0x0, 0x0, 0x0
    .long 0x0, 0x0, 0x0, 0x0
    .long 0x0, 0x0, 0x0, 0x0
    .long 0x0, 0x0, 0x0, 0x0
    .long 0x0, 0x0, 0x0, 0x0
    .long 0x0, 0x0, 0x0, 0x0
    .long 0x0, 0x0, 0x0, 0x0
    .long 0x0, 0x0, 0x0, 0x0
    .long 0x0, 0x0, 0x0, 0x0
    .long 0x0, 0x0, 0x0, 0x0
    .long 0x0, 0x0, 0x0, 0x0
    .long 0x0, 0x0, 0x0, 0x0
    .long 0x3c003c00, 0x3c00, 0x0, 0x0
    .long 0x3c003c00, 0x3c003c00, 0x0, 0x0
    .long 0x3c003c00, 0x3c003c00, 0x3c00, 0x0
    .long 0x3c000000, 0x3c003c00, 0x3c003c00, 0x0
    .long 0x0, 0x3c003c00, 0x3c003c00, 0x3c00
    .long 0x0, 0x3c000000, 0x3c003c00, 0x3c003c00
    .long 0x0, 0x0, 0x3c003c00, 0x3c003c00
    .long 0x0, 0x0, 0x3c000000, 0x3c003c00
    .long 0x0, 0x0, 0x0, 0x3c003c00
    .long 0x0, 0x0, 0x0, 0x3c000000
    .long 0x0, 0x0, 0x0, 0x0
    .long 0x0, 0x0, 0x0, 0x0
    .long 0x0, 0x0, 0x0, 0x0
    .long 0x0, 0x0, 0x0, 0x0
    .long 0x0, 0x0, 0x0, 0x0
    .long 0x0, 0x0, 0x0, 0x0
    .long 0x0, 0x0, 0x0, 0x0
    .long 0x0, 0x0, 0x0, 0x0
    .long 0x0, 0x0, 0x0, 0x0
    .long 0x0, 0x0, 0x0, 0x0
    .long 0x0, 0x0, 0x0, 0x0
    .long 0x0, 0x0, 0x0, 0x0
    .long 0x3c00, 0x0, 0x0, 0x0
    .long 0x3c003c00, 0x0, 0x0, 0x0
    .long 0x3c003c00, 0x3c00, 0x0, 0x0
    .long 0x3c003c00, 0x3c003c00, 0x0, 0x0
    .long 0x3c003c00, 0x3c003c00, 0x3c00, 0x0
    .long 0x3c000000, 0x3c003c00, 0x3c003c00, 0x0
    .long 0x0, 0x3c003c00, 0x3c003c00, 0x3c00
    .long 0x0, 0x3c000000, 0x3c003c00, 0x3c003c00
    .long 0x0, 0x0, 0x3c003c00, 0x3c003c00
    .long 0x0, 0x0, 0x3c000000, 0x3c003c00
    .long 0x0, 0x0, 0x0, 0x0
    .long 0x0, 0x0, 0x0, 0x0
    .long 0x0, 0x0, 0x0, 0x0
    .long 0x0, 0x0, 0x0, 0x0
    .long 0x0, 0x0, 0x0, 0x0
    .long 0x0, 0x0, 0x0, 0x0
    .long 0x0, 0x0, 0x0, 0x0
    .long 0x0, 0x0, 0x0, 0x0
    .long 0x0, 0x0, 0x0, 0x0
    .long 0x0, 0x0, 0x0, 0x0
    .long 0x0, 0x0, 0x0, 0x0
    .long 0x0, 0x0, 0x0, 0x0
    .long 0x0, 0x0, 0x0, 0x0
    .long 0x0, 0x0, 0x0, 0x0
    .long 0x3c00, 0x0, 0x0, 0x0
    .long 0x3c003c00, 0x0, 0x0, 0x0
    .long 0x0, 0x3c000000, 0x3c003c00, 0x0
    .long 0x0, 0x0, 0x3c003c00, 0x3c00
    .long 0x0, 0x0, 0x3c000000, 0x3c003c00
    .long 0x0, 0x0, 0x0, 0x3c003c00
    .long 0x0, 0x0, 0x0, 0x3c000000
    .long 0x0, 0x0, 0x0, 0x0
    .long 0x0, 0x0, 0x0, 0x0
    .long 0x0, 0x0, 0x0, 0x0
    .long 0x0, 0x0, 0x0, 0x0
    .long 0x0, 0x0, 0x0, 0x0
    .long 0x0, 0x0, 0x0, 0x0
    .long 0x0, 0x0, 0x0, 0x0
    .long 0x0, 0x0, 0x0, 0x0
    .long 0x0, 0x0, 0x0, 0x0
    .long 0x0, 0x0, 0x0, 0x0
    .long 0x0, 0x0, 0x0, 0x0
    .long 0x0, 0x0, 0x0, 0x0
    .long 0x0, 0x0, 0x0, 0x0
    .long 0x0, 0x0, 0x0, 0x0
    .long 0x3c00, 0x0, 0x0, 0x0
    .long 0x3c003c00, 0x0, 0x0, 0x0
    .long 0x3c003c00, 0x3c00, 0x0, 0x0
    .long 0x3c000000, 0x3c003c00, 0x0, 0x0
    .long 0x0, 0x3c003c00, 0x3c00, 0x0
    .long 0x0, 0x3c000000, 0x3c003c00, 0x0
    .long 0x0, 0x0, 0x3c003c00, 0x3c00
    .long 0x0, 0x0, 0x3c000000, 0x3c003c00
    .long 0x0, 0x0, 0x0, 0x3c003c00
    .long 0x0, 0x0, 0x0, 0x3c000000
    .long 0x0, 0x0, 0x0, 0x0
    .long 0x0, 0x0, 0x0, 0x0
    .long 0x0, 0x0, 0x0, 0x0
    .long 0x0, 0x0, 0x0, 0x0
    .long 0x0, 0x0, 0x0, 0x0
    .long 0x0, 0x0, 0x0, 0x0
    .long 0x0, 0x0, 0x0, 0x0
    .long 0x0, 0x0, 0x0, 0x0
    .long 0x0, 0x0, 0x0, 0x0
    .long 0x0, 0x0, 0x0, 0x0
    .long 0x0, 0x0, 0x0, 0x0
    .long 0x0, 0x0, 0x0, 0x0
    .long 0x0, 0x0, 0x0, 0x0
    .long 0x0, 0x0, 0x0, 0x0
    .long 0x3c00, 0x0, 0x0, 0x0
    .long 0x3c003c00, 0x0, 0x0, 0x0
    .long 0x3c003c00, 0x3c00, 0x0, 0x0
    .long 0x3c000000, 0x3c003c00, 0x0, 0x0
    .long 0x0, 0x3c003c00, 0x3c00, 0x0
    .long 0x0, 0x0, 0x0, 0x0
    .long 0x0, 0x0, 0x0, 0x0
    .long 0x0, 0x0, 0x0, 0x0
    .long 0x0, 0x0, 0x0, 0x0
    .long 0x0, 0x0, 0x0, 0x0
    .long 0x0, 0x0, 0x0, 0x0
    .long 0x0, 0x0, 0x0, 0x0
    .long 0x0, 0x0, 0x0, 0x0
    .long 0x0, 0x0, 0x0, 0x0
    .long 0x0, 0x0, 0x0, 0x0
    .long 0x0, 0x0, 0x0, 0x0
    .long 0x0, 0x0, 0x0, 0x0
    .long 0x0, 0x0, 0x0, 0x0
    .long 0x0, 0x0, 0x0, 0x0
    .long 0x0, 0x0, 0x0, 0x0
    .long 0x0, 0x0, 0x0, 0x0
    .long 0x0, 0x0, 0x3c000000, 0x3c003c00
    .long 0x0, 0x0, 0x0, 0x3c003c00
    .long 0x0, 0x0, 0x0, 0x3c000000
    .long 0x0, 0x0, 0x0, 0x0
    .long 0x0, 0x0, 0x0, 0x0
    .long 0x0, 0x0, 0x0, 0x0
    .long 0x0, 0x0, 0x0, 0x0
    .long 0x0, 0x0, 0x0, 0x0
    .long 0x0, 0x0, 0x0, 0x0
    .long 0x0, 0x0, 0x0, 0x0
    .long 0x0, 0x0, 0x0, 0x0
    .long 0x0, 0x0, 0x0, 0x0
    .long 0x0, 0x0, 0x0, 0x0
    .long 0x0, 0x0, 0x0, 0x0
    .long 0x0, 0x0, 0x0, 0x0
    .long 0x0, 0x0, 0x0, 0x0
    .long 0x3c003c00, 0x3c003c00, 0x0, 0x0
    .long 0x3c003c00, 0x3c003c00, 0x3c00, 0x0
    .long 0x3c003c00, 0x3c003c00, 0x3c003c00, 0x0
    .long 0x3c003c00, 0x3c003c00, 0x3c003c00, 0x3c00
    .long 0x3c000000, 0x3c003c00, 0x3c003c00, 0x3c003c00
    .long 0x0, 0x3c003c00, 0x3c003c00, 0x3c003c00
    .long 0x0, 0x3c000000, 0x3c003c00, 0x3c003c00
    .long 0x0, 0x0, 0x3c003c00, 0x3c003c00
    .long 0x0, 0x0, 0x3c000000, 0x3c003c00
    .long 0x0, 0x0, 0x0, 0x3c003c00
    .long 0x0, 0x0, 0x0, 0x3c000000
    .long 0x0, 0x0, 0x0, 0x0
    .long 0x0, 0x0, 0x0, 0x0
    .long 0x0, 0x0, 0x0, 0x0
    .long 0x0, 0x0, 0x0, 0x0
    .long 0x0, 0x0, 0x0, 0x0
    .long 0x0, 0x0, 0x0, 0x0
    .long 0x0, 0x0, 0x0, 0x0
    .long 0x0, 0x0, 0x0, 0x0
    .long 0x0, 0x0, 0x0, 0x0
    .long 0x0, 0x0, 0x0, 0x0
    .long 0x3c00, 0x0, 0x0, 0x0
    .long 0x3c003c00, 0x0, 0x0, 0x0
    .long 0x3c003c00, 0x3c00, 0x0, 0x0
    .long 0x3c003c00, 0x3c003c00, 0x0, 0x0
    .long 0x3c003c00, 0x3c003c00, 0x3c00, 0x0
    .long 0x3c003c00, 0x3c003c00, 0x3c003c00, 0x0
    .long 0x3c003c00, 0x3c003c00, 0x3c003c00, 0x3c00
    .long 0x3c000000, 0x3c003c00, 0x3c003c00, 0x3c003c00
    .long 0x0, 0x3c003c00, 0x3c003c00, 0x3c003c00
    .long 0x0, 0x3c000000, 0x3c003c00, 0x3c003c00
    .long 0x0, 0x0, 0x3c003c00, 0x3c003c00
    .long 0x0, 0x0, 0x0, 0x0
    .long 0x0, 0x0, 0x0, 0x0
    .long 0x0, 0x0, 0x0, 0x0
    .long 0x0, 0x0, 0x0, 0x0
    .long 0x0, 0x0, 0x0, 0x0
    .long 0x0, 0x0, 0x0, 0x0
    .long 0x0, 0x0, 0x0, 0x0
    .long 0x0, 0x0, 0x0, 0x0
    .long 0x0, 0x0, 0x0, 0x0
    .long 0x0, 0x0, 0x0, 0x0
    .long 0x0, 0x0, 0x0, 0x0
    .long 0x0, 0x0, 0x0, 0x0
    .long 0x0, 0x0, 0x0, 0x0
    .long 0x3c00, 0x0, 0x0, 0x0
    .long 0x3c003c00, 0x0, 0x0, 0x0
    .long 0x3c003c00, 0x3c00, 0x0, 0x0
    .long 0x0, 0x0, 0x3c003c00, 0x3c003c00
    .long 0x0, 0x0, 0x3c000000, 0x3c003c00
    .long 0x0, 0x0, 0x0, 0x3c003c00
    .long 0x0, 0x0, 0x0, 0x3c000000
    .long 0x0, 0x0, 0x0, 0x0
    .long 0x0, 0x0, 0x0, 0x0
    .long 0x0, 0x0, 0x0, 0x0
    .long 0x0, 0x0, 0x0, 0x0
    .long 0x0, 0x0, 0x0, 0x0
    .long 0x0, 0x0, 0x0, 0x0
    .long 0x0, 0x0, 0x0, 0x0
    .long 0x0, 0x0, 0x0, 0x0
    .long 0x0, 0x0, 0x0, 0x0
    .long 0x0, 0x0, 0x0, 0x0
    .long 0x0, 0x0, 0x0, 0x0
    .long 0x0, 0x0, 0x0, 0x0
    .long 0x3c003c00, 0x3c003c00, 0x3c00, 0x0
    .long 0x3c003c00, 0x3c003c00, 0x3c003c00, 0x0
    .long 0x3c003c00, 0x3c003c00, 0x3c003c00, 0x3c00
    .long 0x3c003c00, 0x3c003c00, 0x3c003c00, 0x3c003c00
    .long 0x3c003c00, 0x3c003c00, 0x3c003c00, 0x3c003c00
    .long 0x3c000000, 0x3c003c00, 0x3c003c00, 0x3c003c00
    .long 0x0, 0x3c003c00, 0x3c003c00, 0x3c003c00
    .long 0x0, 0x3c000000, 0x3c003c00, 0x3c003c00
    .long 0x0, 0x0, 0x3c003c00, 0x3c003c00
    .long 0x0, 0x0, 0x3c000000, 0x3c003c00
    .long 0x0, 0x0, 0x0, 0x3c003c00
    .long 0x0, 0x0, 0x0, 0x3c000000
    .long 0x0, 0x0, 0x0, 0x0
    .long 0x0, 0x0, 0x0, 0x0
    .long 0x0, 0x0, 0x0, 0x0
    .long 0x0, 0x0, 0x0, 0x0
    .long 0x0, 0x0, 0x0, 0x0
    .long 0x0, 0x0, 0x0, 0x0
    .long 0x0, 0x0, 0x0, 0x0
    .long 0x0, 0x0, 0x0, 0x0
    .long 0x3c00, 0x0, 0x0, 0x0
    .long 0x3c003c00, 0x0, 0x0, 0x0
    .long 0x3c003c00, 0x3c00, 0x0, 0x0
    .long 0x3c003c00, 0x3c003c00, 0x0, 0x0
    .long 0x3c003c00, 0x3c003c00, 0x3c00, 0x0
    .long 0x3c003c00, 0x3c003c00, 0x3c003c00, 0x0
    .long 0x3c003c00, 0x3c003c00, 0x3c003c00, 0x3c00
    .long 0x3c003c00, 0x3c003c00, 0x3c003c00, 0x3c003c00
    .long 0x3c003c00, 0x3c003c00, 0x3c003c00, 0x3c003c00
    .long 0x3c000000, 0x3c003c00, 0x3c003c00, 0x3c003c00
    .long 0x0, 0x3c003c00, 0x3c003c00, 0x3c003c00
    .long 0x0, 0x3c000000, 0x3c003c00, 0x3c003c00
    .long 0x0, 0x0, 0x0, 0x0
    .long 0x0, 0x0, 0x0, 0x0
    .long 0x0, 0x0, 0x0, 0x0
    .long 0x0, 0x0, 0x0, 0x0
    .long 0x0, 0x0, 0x0, 0x0
    .long 0x0, 0x0, 0x0, 0x0
    .long 0x0, 0x0, 0x0, 0x0
    .long 0x0, 0x0, 0x0, 0x0
    .long 0x0, 0x0, 0x0, 0x0
    .long 0x0, 0x0, 0x0, 0x0
    .long 0x0, 0x0, 0x0, 0x0
    .long 0x0, 0x0, 0x0, 0x0
    .long 0x3c00, 0x0, 0x0, 0x0
    .long 0x3c003c00, 0x0, 0x0, 0x0
    .long 0x3c003c00, 0x3c00, 0x0, 0x0
    .long 0x3c003c00, 0x3c003c00, 0x0, 0x0
    .long 0x0, 0x0, 0x0, 0x0
    .long 0x0, 0x0, 0x0, 0x0
    .long 0x0, 0x0, 0x0, 0x0
    .long 0x0, 0x0, 0x0, 0x0
    .long 0x0, 0x0, 0x0, 0x0
    .long 0x0, 0x0, 0x0, 0x0
    .long 0x0, 0x0, 0x0, 0x0
    .long 0x0, 0x0, 0x0, 0x0
    .long 0x0, 0x0, 0x0, 0x0
    .long 0x0, 0x0, 0x0, 0x0
    .long 0x0, 0x0, 0x0, 0x0
    .long 0x0, 0x0, 0x0, 0x0
    .long 0x0, 0x0, 0x0, 0x0
    .long 0x0, 0x0, 0x0, 0x0
    .long 0x0, 0x0, 0x0, 0x0
    .long 0x0, 0x0, 0x0, 0x0
    .long 0x0, 0x0, 0xffffffff, 0x0
    .long 0x0, 0x0, 0xffff0000, 0xffff
    .long 0x0, 0x0, 0x0, 0xffffffff
    .long 0x0, 0x0, 0x0, 0xffff0000
    .long 0x0, 0x0, 0x0, 0x0
    .long 0x0, 0x0, 0x0, 0x0
    .long 0x0, 0x0, 0x0, 0x0
    .long 0x0, 0x0, 0x0, 0x0
    .long 0x0, 0x0, 0x0, 0x0
    .long 0x0, 0x0, 0x0, 0x0
    .long 0x0, 0x0, 0x0, 0x0
    .long 0x0, 0x0, 0x0, 0x0
    .long 0x0, 0x0, 0x0, 0x0
    .long 0x0, 0x0, 0x0, 0x0
    .long 0x0, 0x0, 0x0, 0x0
    .long 0x0, 0x0, 0x0, 0x0
    .long 0x0, 0x0, 0x0, 0x0
    .long 0x0, 0x0, 0x0, 0x0
    .long 0x0, 0x0, 0x0, 0x0
    .long 0xffff, 0x0, 0x0, 0x0
    .long 0xffffffff, 0x0, 0x0, 0x0
    .long 0xffff0000, 0xffff, 0x0, 0x0
    .long 0x0, 0xffffffff, 0x0, 0x0
    .long 0x0, 0xffff0000, 0xffff, 0x0
    .long 0x0, 0x0, 0xffffffff, 0x0
    .long 0x0, 0x0, 0xffff0000, 0xffff
    .long 0x0, 0x0, 0x0, 0xffffffff
    .long 0x0, 0x0, 0x0, 0xffff0000
    .long 0x0, 0x0, 0x0, 0x0
    .long 0x0, 0x0, 0x0, 0x0
    .long 0x0, 0x0, 0x0, 0x0
    .long 0x0, 0x0, 0x0, 0x0
    .long 0x0, 0x0, 0x0, 0x0
    .long 0x0, 0x0, 0x0, 0x0
    .long 0x0, 0x0, 0x0, 0x0
    .long 0x0, 0x0, 0x0, 0x0
    .long 0x0, 0x0, 0x0, 0x0
    .long 0x0, 0x0, 0x0, 0x0
    .long 0x0, 0x0, 0x0, 0x0
    .long 0x0, 0x0, 0x0, 0x0
    .long 0x0, 0x0, 0x0, 0x0
    .long 0x0, 0x0, 0x0, 0x0
    .long 0x0, 0x0, 0x0, 0x0
    .long 0xffff, 0x0, 0x0, 0x0
    .long 0xffffffff, 0x0, 0x0, 0x0
    .long 0xffff0000, 0xffff, 0x0, 0x0
    .long 0x0, 0xffffffff, 0x0, 0x0
    .long 0x0, 0xffff0000, 0xffff, 0x0
L_end:
.section .rodata,"a"
.p2align 6
.amdhsa_kernel parallel_sum__ssm_conv_s4__moe_arch_mod__prompt_kernel
  .amdhsa_next_free_vgpr 256
  .amdhsa_next_free_sgpr 100
  .amdhsa_accum_offset 256
  .amdhsa_group_segment_fixed_size 0
  .amdhsa_kernarg_size 136
  .amdhsa_user_sgpr_count 2
  .amdhsa_user_sgpr_kernarg_segment_ptr 1
  .amdhsa_system_sgpr_workgroup_id_x 1
  .amdhsa_float_denorm_mode_32 3
.end_amdhsa_kernel
```
